```python
import torch

def _softmax(x, axis=-1):
    return torch.softmax(x, dim=axis)
def _gelu(x):
    return torch.nn.functional.gelu(x, approximate="tanh")
def _silu(x):
    return torch.nn.functional.silu(x)
def _sigmoid(x):
    return torch.sigmoid(x)
def _layernorm(x, axis=-1, eps=1e-5):
    m = x.mean(dim=axis, keepdim=True)
    v = x.var(dim=axis, keepdim=True, unbiased=False)
    return (x - m) / torch.sqrt(v + eps)
def _scatter_add(tgt, idx, src, axis=0):
    return tgt.clone().index_add_(axis, idx, src)
def _segment_sum(src, seg, n):
    out = torch.zeros((n,) + src.shape[1:], dtype=src.dtype)
    return out.index_add_(0, seg, src)
def _pad(x, pw):
    flat = tuple(v for pair in reversed(pw) for v in pair)
    return torch.nn.functional.pad(x, flat)

kernel_name = 'sequential_preLN__linear_kernel_hedgehog__mixer_token_mlp__prompt'

def setup_inputs():

    _w = (lambda a: (lambda t: t.to(torch.bfloat16) if t.is_floating_point() else t)(torch.as_tensor(a)))
    def _A_setup():
        B, S, D, H = 1, 2048, 448, 16
        Dh = D // H
        return {
            "x": _w((lambda *s: torch.randn(*s, dtype=torch.bfloat16) * 0.05)(B, S, D)),
            "wqkv": _w((lambda *s: torch.randn(*s, dtype=torch.bfloat16) * 0.2)(D, 3 * D)),
            "w_phi": _w((lambda *s: torch.randn(*s, dtype=torch.bfloat16) * 0.2)(H, Dh, Dh) * (Dh ** -0.5)),
            "wo": _w((lambda *s: torch.randn(*s, dtype=torch.bfloat16) * 0.05)(D, D)),
        }
    _A_in = _A_setup()

    def _B_setup():
        B, S, D, F = 1, 2048, 448, 1792
        return {
            "x": _w((lambda *s: torch.randn(*s, dtype=torch.bfloat16) * 0.05)(B, S, D)),
            "w1": _w((lambda *s: torch.randn(*s, dtype=torch.bfloat16) * 0.2)(S, F) * (S ** -0.5)),
            "b1": _w((lambda *s: torch.randn(*s, dtype=torch.bfloat16) * 3.2)(F) * 0.02),
            "w2": _w((lambda *s: torch.randn(*s, dtype=torch.bfloat16) * 0.8)(F, S) * (F ** -0.5)),
            "b2": _w((lambda *s: torch.randn(*s, dtype=torch.bfloat16) * 3.2)(S) * 0.02),
        }
    _B_in = _B_setup()

    return {
        "A_x": _A_in["x"],
        "A_wqkv": _A_in["wqkv"],
        "A_w_phi": _A_in["w_phi"],
        "A_wo": _A_in["wo"],
        "B_x": _B_in["x"],
        "B_w1": _B_in["w1"],
        "B_b1": _B_in["b1"],
        "B_w2": _B_in["w2"],
        "B_b2": _B_in["b2"],
    }

def reference(A_x, A_wqkv, A_w_phi, A_wo, B_x, B_w1, B_b1, B_w2, B_b2):
    def _A_ref(x, wqkv, w_phi, wo):
        B, S, D = x.shape
        H = 16; Dh = D // H
        qkv = (lambda x, *d: x.permute(*d))((x @ wqkv).reshape(B, S, 3, H, Dh), 2, 0, 3, 1, 4)
        q, k, v = qkv[0], qkv[1], qkv[2]
        pq = torch.einsum("bhsd,hdf->bhsf", q, w_phi)
        pk = torch.einsum("bhsd,hdf->bhsf", k, w_phi)
        phi_q = torch.concatenate([_softmax(pq, axis=-1), _softmax(-pq, axis=-1)], axis=-1)
        phi_k = torch.concatenate([_softmax(pk, axis=-1), _softmax(-pk, axis=-1)], axis=-1)
        kv = torch.einsum("bhsf,bhsd->bhfd", phi_k, v)
        z  = torch.einsum("bhsf->bhf", phi_k)
        num = torch.einsum("bhqf,bhfd->bhqd", phi_q, kv)
        den = torch.einsum("bhqf,bhf->bhq", phi_q, z)[..., None] + 1e-6
        o = num / den
        return (lambda x, *d: x.permute(*d))(o, 0, 2, 1, 3).reshape(B, S, D) @ wo

    def _B_ref(x, w1, b1, w2, b2):
        B, S, D = x.shape
        h = _layernorm(x, axis=-1)
        u = torch.einsum("bsd,sf->bdf", h, w1) + b1
        u = _gelu(u)
        y = torch.einsum("bdf,fs->bds", u, w2) + b2
        return (lambda x, *d: x.permute(*d))(y, 0, 2, 1)

    x = A_x
    h = x + _A_ref(_layernorm(x, axis=-1), A_wqkv, A_w_phi, A_wo)
    h2 = h + _B_ref(_layernorm(h, axis=-1), B_w1, B_b1, B_w2, B_b2)
    return h2
```

```asm
; @launch grid=(256,1,1) block=(256,1,1) lds=163840
.amdgcn_target "amdgcn-amd-amdhsa--gfx950"
.text
.globl sequential_preLN__linear_kernel_hedgehog__mixer_token_mlp__prompt_kernel
.p2align 8
.type sequential_preLN__linear_kernel_hedgehog__mixer_token_mlp__prompt_kernel,@function
sequential_preLN__linear_kernel_hedgehog__mixer_token_mlp__prompt_kernel:
    s_cmp_ge_u32 s2, 256
    s_cbranch_scc1 END
    s_load_dwordx16 s[16:31], s[0:1], 0
    s_load_dwordx8 s[32:39], s[0:1], 64
    s_getpc_b64 s[62:63]
PCB:
    s_lshr_b32 s71, s2, 3
    v_lshrrev_b32 v243, 3, v0
    v_lshlrev_b32 v243, 7, v243
    global_load_dword v238, v243, s[62:63]
    v_lshrrev_b32 v242, 5, v0
    v_lshrrev_b32 v244, 6, v0
    v_lshl_add_u32 v242, s71, 3, v242
    v_lshlrev_b32 v242, 7, v242
    v_readfirstlane_b32 s66, v244
    v_min_u32 v242, CODE_END-PCB-4096, v242
    global_load_dword v239, v242, s[62:63] offset:4092
    v_and_b32 v241, 63, v0
    s_and_b32 s70, s2, 7
    s_mul_i32 s69, s66, 40960
    s_and_b32 s3, s71, 7
    s_and_b32 s65, s70, 1
    s_lshl_b32 s65, s65, 3
    s_add_u32 s65, s65, s3
    s_lshr_b32 s78, s71, 3
    s_lshr_b32 s64, s70, 1
    s_lshl_b32 s64, s64, 2
    s_add_u32 s64, s64, s78
    s_lshl_b32 s78, s78, 1
    s_add_u32 s88, s3, s78
    s_cmp_ge_u32 s88, 7
    s_cselect_b32 s3, 7, 0
    s_sub_u32 s88, s88, s3
    s_mov_b32 s60, 0x4f3f2f10
    s_mov_b32 s61, 0x98f7f6f5
    s_lshl_b32 s3, s65, 2
    s_lshr_b64 s[60:61], s[60:61], s3
    s_and_b32 s91, s60, 15
    s_lshl_b32 s91, s91, 4
    s_add_u32 s91, s91, s64
    s_and_b32 s79, s91, 1
    s_mul_i32 s79, s79, 384
    s_mov_b32 s96, s91
    v_and_b32 v245, 31, v241
    v_lshrrev_b32 v246, 5, v241
    v_lshlrev_b32 v250, 4, v241
    v_lshrrev_b32 v242, 2, v241
    v_mul_u32_u24 v242, 2688, v242
    v_and_b32 v248, 3, v241
    v_lshl_add_u32 v242, v248, 4, v242
    s_mul_i32 s3, s65, 56
    s_min_u32 s3, s3, 832
    s_mul_i32 s78, s66, 43008
    s_add_u32 s3, s3, s78
    s_add_u32 s3, s3, 896
    v_add_u32 v92, s3, v242
    v_subrev_u32 v93, 128, v92
    s_mul_i32 s93, s88, 172032
    v_lshrrev_b32 v242, 3, v241
    v_mul_u32_u24 v242, 896, v242
    v_lshrrev_b32 v244, 4, v241
    v_xor_b32 v244, v244, v241
    v_and_b32 v244, 7, v244
    v_lshl_add_u32 v72, v244, 4, v242
    v_xor_b32 v244, 4, v244
    v_lshl_add_u32 v73, v244, 4, v242
    v_add_u32 v74, 12288, v72
    v_add_u32 v75, 18432, v73
    v_add_u32 v73, 6144, v73
    s_lshl_b32 s3, s64, 2
    s_add_u32 s90, s3, s66
    s_mul_i32 s82, s90, 28672
    s_add_u32 s85, s82, 896
    s_lshl_b32 s3, s88, 7
    s_add_u32 s82, s82, s3
    s_cmp_ge_u32 s91, 56
    s_cbranch_scc1 SRC_B
    s_lshr_b32 s92, s91, 1
    s_mul_i32 s83, s92, 43008
    s_add_u32 s83, s83, s79
    s_movk_i32 s80, 2688
    s_waitcnt lgkmcnt(0)
    s_mov_b32 s56, s18
    s_mov_b32 s57, s19
    s_mov_b32 s58, 0x126000
    s_mov_b32 s59, 0x20000
    s_branch SRC_D
SRC_B:
    s_sub_u32 s92, s91, 56
    s_lshr_b32 s92, s92, 1
    s_lshr_b32 s3, s92, 1
    s_mul_i32 s3, s3, 28
    s_and_b32 s78, s92, 1
    s_lshl_b32 s78, s78, 4
    s_add_u32 s3, s3, s78
    s_mul_i32 s83, s3, 896
    s_add_u32 s83, s83, s79
    s_movk_i32 s80, 896
    s_cmp_lt_u32 s91, 120
    s_cselect_b32 s3, 401408, 0
    s_cselect_b32 s83, s83, 0
    s_waitcnt lgkmcnt(0)
    s_mov_b32 s56, s22
    s_mov_b32 s57, s23
    s_mov_b32 s58, s3
    s_mov_b32 s59, 0x20000
SRC_D:
    s_mov_b32 s8, s18
    s_mov_b32 s9, s19
    s_mov_b32 s10, 0x126000
    s_mov_b32 s11, 0x20000
    s_mov_b32 s4, s16
    s_mov_b32 s5, s17
    s_mov_b32 s6, 0x1c0000
    s_mov_b32 s7, 0x20000
    s_add_u32 m0, s69, 16384
    s_nop 0
    buffer_load_dwordx4 v92, s[8:11], s93 offen offset:0 lds
    buffer_load_dwordx4 v93, s[8:11], s93 offen offset:1024 lds
    s_add_u32 m0, s69, 0
    s_nop 0
    buffer_load_dwordx4 v72, s[4:7], s82 offen offset:0 lds
    buffer_load_dwordx4 v73, s[4:7], s82 offen offset:1024 lds
    buffer_load_dwordx4 v74, s[4:7], s82 offen offset:2048 lds
    buffer_load_dwordx4 v75, s[4:7], s82 offen offset:3072 lds
    s_lshl_b32 s3, s66, 2
    v_add_u32 v242, s3, v246
    v_mul_lo_u32 v242, v242, s80
    v_lshl_add_u32 v242, v245, 4, v242
    s_lshl_b32 s3, s80, 1
    s_sub_u32 s3, s3, 1024
    v_add_u32 v76, s3, v242
    s_add_u32 m0, s69, 36864
    s_load_dword s67, s[38:39], 0
    buffer_load_dwordx4 v242, s[56:59], s83 offen lds
    buffer_load_dwordx4 v76, s[56:59], s83 offen offset:1024 lds
    s_mov_b32 s52, s20
    s_mov_b32 s53, s21
    s_mov_b32 s54, 0x6200
    s_mov_b32 s55, 0x20000
    s_and_b32 s3, s66, 1
    s_lshl_b32 s3, s3, 10
    s_add_u32 m0, s3, 30720
    s_mul_i32 s78, s65, 1568
    s_add_u32 s3, s3, s78
    buffer_load_dwordx4 v250, s[52:55], s3 offen lds
    s_mov_b32 s12, s38
    s_mov_b32 s13, s39
    s_mov_b32 s14, 0x1000000
    s_mov_b32 s15, 0x20000
    v_mov_b32 v108, -1
    v_mov_b32 v109, -1
    v_mov_b32 v110, -1
    v_mov_b32 v111, -1
    s_lshl_b32 s90, s90, 4
    s_add_u32 s90, s90, s65
    s_lshl_b32 s90, s90, 11
    s_add_u32 s90, s90, 3145728
    s_lshl_b32 s3, s65, 2
    s_add_u32 s3, s3, s66
    s_lshl_b32 s3, s3, 4
    s_add_u32 s3, s3, s64
    s_lshl_b32 s89, s3, 10
    s_add_u32 s89, s89, 2097152
    s_mov_b32 s60, 0
    s_mov_b32 s61, -1
    v_bfe_u32 v247, v241, 2, 2
    v_bfe_u32 v249, v241, 4, 1
    v_mov_b32 v252, 0
    v_mov_b32 v225, 0x3f803f80
    s_and_b32 s79, s96, 1
    s_mov_b64 s[98:99], 0
    s_cmp_eq_u32 s80, 896
    s_cbranch_scc1 PAR_B
    s_mov_b32 s40, 81920
    s_movk_i32 s41, 512
    s_mov_b32 s42, 40960
    s_movk_i32 s43, 56
    s_movk_i32 s44, 6
    s_movk_i32 s46, 28
    s_lshl_b32 s3, s79, 2
    s_add_u32 s3, s3, s66
    s_mul_i32 s45, s3, 112
    s_mul_i32 s78, s79, 384
    s_sub_u32 s45, s45, s78
    s_mul_i32 s94, s3, 168
    s_add_u32 s94, s94, s92
    s_lshl_b32 s94, s94, 10
    s_add_u32 s94, s94, 11591680
    s_add_u32 s95, s94, 86016
    s_branch PAR_D
PAR_B:
    s_mov_b32 s40, 40960
    s_movk_i32 s41, 512
    s_mov_b32 s42, 81920
    s_movk_i32 s44, 7
    s_movk_i32 s46, 32
    s_and_b32 s3, s66, 1
    s_cselect_b32 s43, 32, 64
    s_lshl_b32 s45, s3, 7
    s_lshl_b32 s3, s79, 1
    s_lshr_b32 s78, s66, 1
    s_add_u32 s3, s3, s78
    s_mul_i32 s78, s3, 224
    s_add_u32 s45, s45, s78
    s_mul_i32 s78, s79, 384
    s_sub_u32 s45, s45, s78
    s_lshl_b32 s3, s79, 2
    s_add_u32 s3, s3, s66
    s_lshl_b32 s94, s3, 6
    s_add_u32 s94, s94, s92
    s_lshl_b32 s94, s94, 10
    s_add_u32 s94, s94, 13631488
    s_add_u32 s95, s94, 32768
    s_bitcmp1_b32 s92, 0
    s_cselect_b64 s[98:99], s[60:61], 0
PAR_D:
    s_cmp_eq_u32 s58, 0
    s_cselect_b32 s3, 0x10000000, 0
    v_add_u32 v224, s3, v250
    s_cselect_b32 s94, 0, s94
    s_cselect_b32 s95, 0, s95
    v_mov_b32 v102, s3
    s_cmp_lt_u32 s96, 151
    s_cselect_b32 s3, 0, 0x10000000
    v_add_u32 v119, s3, v250
    s_lshl_b32 s96, s96, 2
    s_add_u32 s97, s96, s66
    s_mul_i32 s97, s97, 9216
    s_add_u32 s97, s97, 3145728
    s_add_u32 s96, s96, 65536
    v_lshl_add_u32 v242, v249, 2, v248
    v_min_u32 v242, s44, v242
    v_lshlrev_b32 v242, 3, v242
    v_mad_u32_u24 v242, v246, s40, v242
    v_mad_u32_u24 v242, v247, s41, v242
    s_add_u32 s3, s45, 36864
    v_add_u32 v208, s3, v242
    v_add_u32 v209, s42, v208
    v_add_u32 v210, s43, v208
    v_add_u32 v211, s42, v210
    s_cmp_eq_u32 s46, 28
    s_cselect_b32 s100, 0xf0000000, 0
    s_mov_b32 s101, s100
    s_add_u32 s3, s69, 38912
    v_lshl_add_u32 v221, v245, 2, s3
    v_lshl_add_u32 v220, v246, 2, v248
    v_lshl_add_u32 v220, v220, 4, s3
    v_mov_b32 v222, 0
    v_mov_b32 v223, 0
    s_mov_b32 s52, s28
    s_mov_b32 s53, s29
    s_mov_b32 s54, 0xe00
    s_mov_b32 s55, 0x20000
    s_mov_b32 s56, s32
    s_mov_b32 s57, s33
    s_mov_b32 s58, 0x1000
    s_mov_b32 s59, 0x20000
    s_mov_b32 s48, s34
    s_mov_b32 s49, s35
    s_mov_b32 s50, 0x1c0000
    s_mov_b32 s51, 0x20000
    v_add_u32 v253, s69, v250
    v_add_u32 v254, 81920, v250
    v_and_b32 v255, 15, v241
    v_lshlrev_b32 v255, 4, v255
    v_lshl_add_u32 v255, v246, 8, v255
    v_lshrrev_b32 v242, 1, v245
    v_and_b32 v242, 7, v242
    v_xor_b32 v242, v242, v246
    v_lshlrev_b32 v242, 4, v242
    v_lshl_add_u32 v242, v245, 7, v242
    v_add_u32 v76, s69, v242
    v_xor_b32 v77, 32, v76
    v_xor_b32 v78, 64, v76
    v_xor_b32 v79, 96, v76
    v_lshl_add_u32 v242, v246, 3, v247
    v_lshlrev_b32 v242, 6, v242
    v_lshl_add_u32 v243, v249, 2, v248
    v_min_u32 v243, 6, v243
    v_lshl_add_u32 v242, v243, 3, v242
    s_cmp_eq_u32 s65, 15
    s_cselect_b32 s3, 8, 0
    s_add_u32 s3, s3, 16384
    v_add_u32 v104, s3, v242
    v_add_u32 v105, 81920, v104
    s_lshl_b32 s75, s70, 3
    s_lshr_b32 s3, s71, 2
    s_add_u32 s75, s75, s3
    s_and_b32 s76, s71, 3
    s_lshl_b32 s3, s66, 1
    s_min_u32 s3, s3, 5
    s_mul_i32 s77, s76, 7
    s_add_u32 s77, s77, s3
    s_mul_i32 s3, s71, 37
    s_lshr_b32 s3, s3, 8
    s_mul_i32 s78, s3, 7
    s_sub_u32 s72, s71, s78
    s_min_u32 s3, s3, 3
    s_lshl_b32 s74, s70, 2
    s_add_u32 s74, s74, s3
    s_mul_i32 s78, s70, 3
    s_add_u32 s78, s78, 4
    s_min_u32 s79, s3, 2
    s_add_u32 s78, s78, s79
    s_cmp_lt_u32 s70, 4
    s_cselect_b32 s73, s74, s78
    s_cmp_ge_u32 s71, 21
    s_cselect_b32 s3, 21, 0
    s_sub_u32 s3, s71, s3
    s_mul_i32 s78, s3, 43
    s_lshr_b32 s78, s78, 7
    s_mul_i32 s79, s78, 3
    s_sub_u32 s3, s3, s79
    s_add_u32 s3, s3, 4
    s_and_b32 s92, s71, 3
    s_lshr_b32 s79, s71, 2
    s_min_u32 s79, s79, 6
    s_bitcmp1_b32 s70, 0
    s_cselect_b32 s92, s3, s92
    s_cselect_b32 s78, s78, s79
    s_lshr_b32 s3, s70, 1
    s_mul_i32 s3, s3, 7
    s_add_u32 s73, s3, s78
    s_mul_i32 s86, s66, 229376
    s_lshl_b32 s3, s73, 7
    s_add_u32 s86, s86, s3
    s_mul_i32 s87, s66, 917504
    s_lshl_b32 s3, s70, 2
    s_add_u32 s3, s3, s72
    s_lshl_b32 s3, s3, 7
    s_add_u32 s79, s87, s3
    s_lshl_b32 s3, s74, 7
    s_add_u32 s87, s87, s3
    s_lshl_b32 s81, s92, 1
    s_mul_i32 s3, s92, 3
    s_sub_u32 s3, s3, 11
    s_cmp_ge_u32 s92, 4
    s_cselect_b32 s81, s3, s81
    s_cmp_ge_u32 s71, 28
    s_cselect_b32 s40, s30, s26
    s_cselect_b32 s41, s31, s27
    s_cselect_b32 s86, s79, s86
    s_cselect_b32 s81, 0, s81
    s_cselect_b32 s46, 0, 7340032
    s_movk_i32 s83, 3584
    s_cselect_b32 s83, 4096, s83
    s_mov_b32 s42, 7340032
    s_mov_b32 s43, 0x20000
    s_mov_b32 s44, s30
    s_mov_b32 s45, s31
    s_mov_b32 s47, 0x20000
    s_cselect_b32 s22, 0, 1
    s_cselect_b32 s23, 15, 7
    s_cselect_b32 s24, 0, 6
    s_and_b32 s16, s66, 1
    s_lshr_b32 s17, s66, 1
    s_lshl_b32 s20, s83, 5
    s_lshl_b32 s18, s77, 6
    s_add_u32 s18, s18, s75
    s_lshl_b32 s18, s18, 10
    s_lshl_b32 s3, s92, 1
    s_add_u32 s3, s3, s16
    s_mul_i32 s3, s3, 114688
    s_lshl_b32 s78, s73, 1
    s_add_u32 s78, s78, s17
    s_lshl_b32 s78, s78, 10
    s_add_u32 s3, s3, s78
    s_add_u32 s19, s3, 7077888
    v_xor_b32 v242, v247, v249
    v_and_b32 v242, 1, v242
    v_or_b32 v242, v242, v248
    v_cmp_eq_u32 vcc, 0, v242
    s_nop 1
    v_cndmask_b32 v94, 0, v225, vcc
    v_cndmask_b32 v95, 0, v225, vcc
    v_cndmask_b32 v96, 0, v225, vcc
    v_cndmask_b32 v97, 0, v225, vcc
    s_mul_i32 s78, s65, 86016
    s_lshl_b32 s3, s66, 10
    s_add_u32 s78, s78, s3
    s_add_u32 s78, s78, 11591680
    s_add_u32 s79, s78, 28672
    s_lshl_b32 s3, s88, 12
    s_add_u32 s25, s78, s3
    s_add_u32 s26, s25, 4096
    s_cmp_ge_u32 s26, s79
    s_cselect_b32 s3, 28672, 0
    s_sub_u32 s26, s26, s3
    s_add_u32 s27, s26, 4096
    s_cmp_ge_u32 s27, s79
    s_cselect_b32 s3, 28672, 0
    s_sub_u32 s27, s27, s3
    s_add_u32 s28, s27, 4096
    s_cmp_ge_u32 s28, s79
    s_cselect_b32 s3, 28672, 0
    s_sub_u32 s28, s28, s3
    s_add_u32 s29, s28, 4096
    s_cmp_ge_u32 s29, s79
    s_cselect_b32 s3, 28672, 0
    s_sub_u32 s29, s29, s3
    s_add_u32 s30, s29, 4096
    s_cmp_ge_u32 s30, s79
    s_cselect_b32 s3, 28672, 0
    s_sub_u32 s30, s30, s3
    s_add_u32 s31, s30, 4096
    s_cmp_ge_u32 s31, s79
    s_cselect_b32 s3, 28672, 0
    s_sub_u32 s31, s31, s3
    s_sub_u32 s26, s26, 1024
    s_sub_u32 s27, s27, 2048
    s_sub_u32 s28, s28, 3072
    s_sub_u32 s30, s30, 1024
    s_sub_u32 s31, s31, 2048
    s_lshl_b32 s3, s64, 10
    s_sub_u32 s32, s89, s3
    s_lshl_b32 s3, s76, 2
    s_add_u32 s3, s3, s66
    s_lshl_b32 s33, s3, 15
    s_add_u32 s33, s33, 13631488
    v_lshrrev_b32 v242, 3, v241
    v_mul_lo_u32 v242, v242, s83
    s_lshl_b32 s3, s83, 3
    s_sub_u32 s3, s3, 1024
    v_and_b32 v243, 7, v241
    v_lshlrev_b32 v244, 2, v249
    v_xor_b32 v243, v243, v244
    v_lshl_add_u32 v84, v243, 4, v242
    v_add_u32 v85, s3, v84
    v_add_u32 v86, s3, v85
    v_add_u32 v87, s3, v86
    v_lshl_add_u32 v242, v246, 3, v247
    v_lshlrev_b32 v242, 7, v242
    v_lshrrev_b32 v243, 1, v247
    v_xor_b32 v243, s17, v243
    v_lshl_add_u32 v242, v243, 6, v242
    v_lshl_add_u32 v242, v249, 5, v242
    v_lshl_add_u32 v242, v248, 3, v242
    v_add_u32 v88, s69, v242
    v_xor_b32 v89, 64, v88
    v_lshlrev_b32 v242, 3, v246
    v_add_u32 v242, s69, v242
    v_mov_b32 v243, 136
    v_mad_u32_u24 v112, v245, v243, v242
    v_mov_b32 v243, 72
    v_mad_u32_u24 v113, v245, v243, v242
    v_lshrrev_b32 v242, 4, v241
    v_lshl_add_u32 v242, v242, 3, v247
    v_lshlrev_b32 v244, 3, v248
    v_mad_u32_u24 v116, v242, v243, v244
    s_lshl_b32 s3, s66, 5
    v_add_u32 v244, s3, v244
    v_mov_b32 v243, 136
    v_mad_u32_u24 v114, v242, v243, v244
    v_add_u32 v117, 81920, v116
    v_add_u32 v115, 81920, v114
    v_cndmask_b32 v106, 1.0, 0, s[60:61]
    s_waitcnt lgkmcnt(0)
    s_mul_i32 s67, s67, 0x9E3779B1
    s_add_u32 s67, s67, 0x7F4A7C15
    s_xor_b32 s68, s67, 0x5bd1e995
    v_mov_b32 v251, s67
    v_min_u32 v107, 59, v241
    v_lshlrev_b32 v107, 3, v107
    v_min_u32 v242, 27, v245
    v_cmp_lt_u32 vcc, 15, v242
    v_mov_b32 v243, 448
    s_nop 0
    v_cndmask_b32 v243, v252, v243, vcc
    v_lshl_add_u32 v242, v242, 2, v243
    v_add_u32 v242, 16832, v242
    v_mov_b32 v243, 40960
    v_mad_u32_u24 v100, v246, v243, v242
    v_add_u32 v101, 81920, v100
    v_lshlrev_b32 v242, 3, v246
    v_sub_u32 v242, v245, v242
    s_lshl_b32 s3, s16, 2
    s_sub_u32 s3, 16, s3
    v_cmp_gt_u32 vcc, s3, v245
    s_nop 1
    v_cndmask_b32 v242, -1, v242, vcc
    v_mov_b32 v243, 0x3f80
    v_mov_b32 v244, 0x3f800000
    v_cmp_eq_u32 vcc, 0, v242
    s_nop 1
    v_cndmask_b32 v120, 0, v243, vcc
    v_cmp_eq_u32 vcc, 1, v242
    s_nop 1
    v_cndmask_b32 v120, v120, v244, vcc
    v_cmp_eq_u32 vcc, 2, v242
    s_nop 1
    v_cndmask_b32 v121, 0, v243, vcc
    v_cmp_eq_u32 vcc, 3, v242
    s_nop 1
    v_cndmask_b32 v121, v121, v244, vcc
    v_cmp_eq_u32 vcc, 4, v242
    s_nop 1
    v_cndmask_b32 v122, 0, v243, vcc
    v_cmp_eq_u32 vcc, 5, v242
    s_nop 1
    v_cndmask_b32 v122, v122, v244, vcc
    v_cmp_eq_u32 vcc, 6, v242
    s_nop 1
    v_cndmask_b32 v123, 0, v243, vcc
    v_cmp_eq_u32 vcc, 7, v242
    s_nop 1
    v_cndmask_b32 v123, v123, v244, vcc
    s_add_u32 s82, s82, 128
    s_add_u32 s93, s93, 172032
    s_cmp_eq_u32 s82, s85
    s_cselect_b32 s91, 896, 0
    s_cselect_b32 s93, 0, s93
    s_sub_u32 s82, s82, s91
    s_add_u32 m0, s69, 18432
    s_nop 0
    buffer_load_dwordx4 v92, s[8:11], s93 offen offset:0 lds
    s_add_u32 m0, s69, 4096
    s_nop 0
    buffer_load_dwordx4 v72, s[4:7], s82 offen offset:0 lds
    buffer_load_dwordx4 v73, s[4:7], s82 offen offset:1024 lds
    s_add_u32 m0, s69, 18432
    s_nop 0
    buffer_load_dwordx4 v93, s[8:11], s93 offen offset:1024 lds
    s_add_u32 m0, s69, 4096
    s_nop 0
    buffer_load_dwordx4 v74, s[4:7], s82 offen offset:2048 lds
    buffer_load_dwordx4 v75, s[4:7], s82 offen offset:3072 lds
    s_add_u32 s82, s82, 128
    s_add_u32 s93, s93, 172032
    s_cmp_eq_u32 s82, s85
    s_cselect_b32 s91, 896, 0
    s_cselect_b32 s93, 0, s93
    s_sub_u32 s82, s82, s91
    s_add_u32 m0, s69, 20480
    s_nop 0
    buffer_load_dwordx4 v92, s[8:11], s93 offen offset:0 lds
    s_add_u32 m0, s69, 8192
    s_nop 0
    buffer_load_dwordx4 v72, s[4:7], s82 offen offset:0 lds
    buffer_load_dwordx4 v73, s[4:7], s82 offen offset:1024 lds
    s_add_u32 m0, s69, 20480
    s_nop 0
    buffer_load_dwordx4 v93, s[8:11], s93 offen offset:1024 lds
    s_add_u32 m0, s69, 8192
    s_nop 0
    buffer_load_dwordx4 v74, s[4:7], s82 offen offset:2048 lds
    buffer_load_dwordx4 v75, s[4:7], s82 offen offset:3072 lds
    s_waitcnt vmcnt(12)
    s_barrier
    ds_read_b64_tr_b16 v[212:213], v208
    ds_read_b64_tr_b16 v[214:215], v209
    ds_read_b64_tr_b16 v[216:217], v210
    ds_read_b64_tr_b16 v[218:219], v211
    ds_read_b128 v[128:131], v76 offset:0
    ds_read_b64_tr_b16 v[32:33], v104 offset:0
    ds_read_b64_tr_b16 v[34:35], v104 offset:256
    ds_read_b128 v[132:135], v77 offset:0
    ds_read_b64_tr_b16 v[36:37], v104 offset:1024
    ds_read_b64_tr_b16 v[38:39], v104 offset:1280
    ds_read_b128 v[136:139], v78 offset:0
    ds_read_b64_tr_b16 v[40:41], v104 offset:40960
    ds_read_b64_tr_b16 v[42:43], v104 offset:41216
    s_waitcnt lgkmcnt(6)
    v_mfma_f32_32x32x16_bf16 v[0:15], v[32:35], v[128:131], 0
    v_cndmask_b32 v214, v214, 0, s[98:99]
    v_cndmask_b32 v215, v215, 0, s[98:99]
    v_cndmask_b32 v218, v218, 0, s[98:99]
    v_cndmask_b32 v219, v219, 0, s[98:99]
    v_dot2c_f32_bf16 v222, v225, v212
    v_dot2c_f32_bf16 v223, v225, v216
    v_dot2c_f32_bf16 v222, v225, v213
    v_dot2c_f32_bf16 v223, v225, v217
    v_dot2c_f32_bf16 v222, v225, v214
    v_dot2c_f32_bf16 v223, v225, v218
    v_dot2c_f32_bf16 v222, v225, v215
    v_dot2c_f32_bf16 v223, v225, v219
    s_nop 1
    v_mov_b32 v242, v222
    v_mov_b32 v243, v223
    s_nop 0
    v_permlane32_swap_b32 v242, v222
    v_permlane32_swap_b32 v243, v223
    v_add_f32 v222, v222, v242
    v_add_f32 v223, v223, v243
    ds_write_b32 v221, v222
    ds_write_b32 v221, v223 offset:128
    s_mov_b64 exec, s[100:101]
    ds_read_b128 v[212:215], v220
    ds_read_b128 v[216:219], v220 offset:128
    s_mov_b64 exec, -1
    v_mfma_f32_16x16x32_bf16 v[64:67], v[94:97], v[32:35], 0
    v_mfma_f32_32x32x16_bf16 a[0:15], v[128:131], v[128:131], 0
    v_mfma_f32_16x16x32_bf16 v[124:127], v[94:97], v[128:131], 0
    ds_read_b128 v[140:143], v79 offset:0
    ds_read_b64_tr_b16 v[44:45], v104 offset:41984
    ds_read_b64_tr_b16 v[46:47], v104 offset:42240
    s_waitcnt lgkmcnt(10)
    v_mfma_f32_32x32x16_bf16 v[16:31], v[36:39], v[128:131], 0
    s_waitcnt lgkmcnt(4)
    buffer_store_dwordx4 v[212:215], v224, s[12:15], s94 offen sc1
    s_waitcnt lgkmcnt(3)
    buffer_store_dwordx4 v[216:219], v224, s[12:15], s95 offen sc1
    v_mfma_f32_16x16x32_bf16 v[68:71], v[94:97], v[36:39], 0
    v_mfma_f32_32x32x16_bf16 a[0:15], v[132:135], v[132:135], a[0:15]
    v_mfma_f32_16x16x32_bf16 v[124:127], v[94:97], v[132:135], v[124:127]
    ds_read_b64_tr_b16 v[48:49], v105 offset:0
    ds_read_b64_tr_b16 v[50:51], v105 offset:256
    v_mfma_f32_32x32x16_bf16 v[0:15], v[40:43], v[132:135], v[0:15]
    s_add_u32 s82, s82, 128
    s_add_u32 s93, s93, 172032
    s_cmp_eq_u32 s82, s85
    s_cselect_b32 s91, 896, 0
    s_cselect_b32 s93, 0, s93
    s_sub_u32 s82, s82, s91
    s_add_u32 m0, s69, 22528
    s_nop 0
    buffer_load_dwordx4 v92, s[8:11], s93 offen offset:0 lds
    s_add_u32 m0, s69, 12288
    s_nop 0
    buffer_load_dwordx4 v72, s[4:7], s82 offen offset:0 lds
    v_mfma_f32_16x16x32_bf16 v[64:67], v[94:97], v[40:43], v[64:67]
    v_mfma_f32_32x32x16_bf16 a[0:15], v[136:139], v[136:139], a[0:15]
    v_mfma_f32_16x16x32_bf16 v[124:127], v[94:97], v[136:139], v[124:127]
    ds_read_b64_tr_b16 v[52:53], v105 offset:1024
    ds_read_b64_tr_b16 v[54:55], v105 offset:1280
    s_waitcnt lgkmcnt(4)
    v_mfma_f32_32x32x16_bf16 v[16:31], v[44:47], v[132:135], v[16:31]
    buffer_load_dwordx4 v73, s[4:7], s82 offen offset:1024 lds
    s_add_u32 m0, s69, 22528
    s_nop 0
    buffer_load_dwordx4 v93, s[8:11], s93 offen offset:1024 lds
    v_mfma_f32_16x16x32_bf16 v[68:71], v[94:97], v[44:47], v[68:71]
    v_mfma_f32_32x32x16_bf16 a[0:15], v[140:143], v[140:143], a[0:15]
    v_mfma_f32_16x16x32_bf16 v[124:127], v[94:97], v[140:143], v[124:127]
    ds_read_b64_tr_b16 v[56:57], v105 offset:40960
    ds_read_b64_tr_b16 v[58:59], v105 offset:41216
    s_waitcnt lgkmcnt(4)
    v_mfma_f32_32x32x16_bf16 v[0:15], v[48:51], v[136:139], v[0:15]
    s_add_u32 m0, s69, 12288
    s_nop 0
    buffer_load_dwordx4 v74, s[4:7], s82 offen offset:2048 lds
    v_mfma_f32_16x16x32_bf16 v[64:67], v[94:97], v[48:51], v[64:67]
    ds_read_b64_tr_b16 v[60:61], v105 offset:41984
    ds_read_b64_tr_b16 v[62:63], v105 offset:42240
    s_waitcnt lgkmcnt(4)
    v_mfma_f32_32x32x16_bf16 v[16:31], v[52:55], v[136:139], v[16:31]
    buffer_load_dwordx4 v75, s[4:7], s82 offen offset:3072 lds
    v_mfma_f32_16x16x32_bf16 v[68:71], v[94:97], v[52:55], v[68:71]
    s_waitcnt vmcnt(14)
    s_barrier
    ds_read_b128 v[144:147], v76 offset:4096
    ds_read_b64_tr_b16 v[32:33], v104 offset:2048
    ds_read_b64_tr_b16 v[34:35], v104 offset:2304
    s_waitcnt lgkmcnt(5)
    v_mfma_f32_32x32x16_bf16 v[0:15], v[56:59], v[140:143], v[0:15]
    s_add_u32 s82, s82, 128
    s_add_u32 s93, s93, 172032
    s_cmp_eq_u32 s82, s85
    s_cselect_b32 s91, 896, 0
    s_cselect_b32 s93, 0, s93
    s_sub_u32 s82, s82, s91
    s_add_u32 m0, s69, 24576
    s_nop 0
    buffer_load_dwordx4 v92, s[8:11], s93 offen offset:0 lds
    v_mfma_f32_16x16x32_bf16 v[64:67], v[94:97], v[56:59], v[64:67]
    ds_read_b128 v[148:151], v77 offset:4096
    ds_read_b64_tr_b16 v[36:37], v104 offset:3072
    ds_read_b64_tr_b16 v[38:39], v104 offset:3328
    s_waitcnt lgkmcnt(6)
    v_mfma_f32_32x32x16_bf16 v[16:31], v[60:63], v[140:143], v[16:31]
    s_add_u32 m0, s69, 0
    s_nop 0
    buffer_load_dwordx4 v72, s[4:7], s82 offen offset:0 lds
    v_mfma_f32_16x16x32_bf16 v[68:71], v[94:97], v[60:63], v[68:71]
    s_waitcnt lgkmcnt(5)
    v_mfma_f32_32x32x16_bf16 a[0:15], v[144:147], v[144:147], a[0:15]
    v_mfma_f32_16x16x32_bf16 v[124:127], v[94:97], v[144:147], v[124:127]
    ds_read_b128 v[152:155], v78 offset:4096
    ds_read_b64_tr_b16 v[40:41], v104 offset:43008
    ds_read_b64_tr_b16 v[42:43], v104 offset:43264
    s_waitcnt lgkmcnt(6)
    v_mfma_f32_32x32x16_bf16 v[0:15], v[32:35], v[144:147], v[0:15]
    buffer_load_dwordx4 v73, s[4:7], s82 offen offset:1024 lds
    v_mfma_f32_16x16x32_bf16 v[64:67], v[94:97], v[32:35], v[64:67]
    s_waitcnt lgkmcnt(5)
    v_mfma_f32_32x32x16_bf16 a[0:15], v[148:151], v[148:151], a[0:15]
    v_mfma_f32_16x16x32_bf16 v[124:127], v[94:97], v[148:151], v[124:127]
    ds_read_b128 v[156:159], v79 offset:4096
    ds_read_b64_tr_b16 v[44:45], v104 offset:44032
    ds_read_b64_tr_b16 v[46:47], v104 offset:44288
    s_waitcnt lgkmcnt(6)
    v_mfma_f32_32x32x16_bf16 v[16:31], v[36:39], v[144:147], v[16:31]
    buffer_store_dwordx4 v[108:111], v250, s[12:15], s89 offen offset:0 sc1
    v_mfma_f32_16x16x32_bf16 v[68:71], v[94:97], v[36:39], v[68:71]
    s_waitcnt lgkmcnt(5)
    v_mfma_f32_32x32x16_bf16 a[0:15], v[152:155], v[152:155], a[0:15]
    v_mfma_f32_16x16x32_bf16 v[124:127], v[94:97], v[152:155], v[124:127]
    ds_read_b64_tr_b16 v[48:49], v105 offset:2048
    ds_read_b64_tr_b16 v[50:51], v105 offset:2304
    s_waitcnt lgkmcnt(5)
    v_mfma_f32_32x32x16_bf16 v[0:15], v[40:43], v[148:151], v[0:15]
    s_add_u32 m0, s69, 24576
    s_nop 0
    buffer_load_dwordx4 v93, s[8:11], s93 offen offset:1024 lds
    v_mfma_f32_16x16x32_bf16 v[64:67], v[94:97], v[40:43], v[64:67]
    s_waitcnt lgkmcnt(4)
    v_mfma_f32_32x32x16_bf16 a[0:15], v[156:159], v[156:159], a[0:15]
    v_mfma_f32_16x16x32_bf16 v[124:127], v[94:97], v[156:159], v[124:127]
    ds_read_b64_tr_b16 v[52:53], v105 offset:3072
    ds_read_b64_tr_b16 v[54:55], v105 offset:3328
    s_waitcnt lgkmcnt(4)
    v_mfma_f32_32x32x16_bf16 v[16:31], v[44:47], v[148:151], v[16:31]
    s_add_u32 m0, s69, 0
    s_nop 0
    buffer_load_dwordx4 v74, s[4:7], s82 offen offset:2048 lds
    v_mfma_f32_16x16x32_bf16 v[68:71], v[94:97], v[44:47], v[68:71]
    ds_read_b64_tr_b16 v[56:57], v105 offset:43008
    ds_read_b64_tr_b16 v[58:59], v105 offset:43264
    s_waitcnt lgkmcnt(4)
    v_mfma_f32_32x32x16_bf16 v[0:15], v[48:51], v[152:155], v[0:15]
    buffer_load_dwordx4 v75, s[4:7], s82 offen offset:3072 lds
    v_mfma_f32_16x16x32_bf16 v[64:67], v[94:97], v[48:51], v[64:67]
    ds_read_b64_tr_b16 v[60:61], v105 offset:44032
    ds_read_b64_tr_b16 v[62:63], v105 offset:44288
    s_waitcnt lgkmcnt(4)
    v_mfma_f32_32x32x16_bf16 v[16:31], v[52:55], v[152:155], v[16:31]
    v_mfma_f32_16x16x32_bf16 v[68:71], v[94:97], v[52:55], v[68:71]
    s_waitcnt vmcnt(15)
    s_waitcnt vmcnt(13)
    s_barrier
    s_cmp_lg_u32 s66, 0
    s_cbranch_scc1 NOFLAG
    buffer_store_dword v251, v102, s[12:15], s96 offen sc1
NOFLAG:
    ds_read_b128 v[160:163], v76 offset:8192
    ds_read_b64_tr_b16 v[32:33], v104 offset:4096
    ds_read_b64_tr_b16 v[34:35], v104 offset:4352
    s_waitcnt lgkmcnt(5)
    v_mfma_f32_32x32x16_bf16 v[0:15], v[56:59], v[156:159], v[0:15]
    s_add_u32 s82, s82, 128
    s_add_u32 s93, s93, 172032
    s_cmp_eq_u32 s82, s85
    s_cselect_b32 s91, 896, 0
    s_cselect_b32 s93, 0, s93
    s_sub_u32 s82, s82, s91
    s_add_u32 m0, s69, 26624
    s_nop 0
    buffer_load_dwordx4 v92, s[8:11], s93 offen offset:0 lds
    v_mfma_f32_16x16x32_bf16 v[64:67], v[94:97], v[56:59], v[64:67]
    ds_read_b128 v[164:167], v77 offset:8192
    ds_read_b64_tr_b16 v[36:37], v104 offset:5120
    ds_read_b64_tr_b16 v[38:39], v104 offset:5376
    s_waitcnt lgkmcnt(6)
    v_mfma_f32_32x32x16_bf16 v[16:31], v[60:63], v[156:159], v[16:31]
    s_add_u32 m0, s69, 4096
    s_nop 0
    buffer_load_dwordx4 v72, s[4:7], s82 offen offset:0 lds
    v_mfma_f32_16x16x32_bf16 v[68:71], v[94:97], v[60:63], v[68:71]
    s_waitcnt lgkmcnt(5)
    v_mfma_f32_32x32x16_bf16 a[0:15], v[160:163], v[160:163], a[0:15]
    v_mfma_f32_16x16x32_bf16 v[124:127], v[94:97], v[160:163], v[124:127]
    ds_read_b128 v[168:171], v78 offset:8192
    ds_read_b64_tr_b16 v[40:41], v104 offset:45056
    ds_read_b64_tr_b16 v[42:43], v104 offset:45312
    s_waitcnt lgkmcnt(6)
    v_mfma_f32_32x32x16_bf16 v[0:15], v[32:35], v[160:163], v[0:15]
    buffer_load_dwordx4 v73, s[4:7], s82 offen offset:1024 lds
    v_mfma_f32_16x16x32_bf16 v[64:67], v[94:97], v[32:35], v[64:67]
    s_waitcnt lgkmcnt(5)
    v_mfma_f32_32x32x16_bf16 a[0:15], v[164:167], v[164:167], a[0:15]
    v_mfma_f32_16x16x32_bf16 v[124:127], v[94:97], v[164:167], v[124:127]
    ds_read_b128 v[172:175], v79 offset:8192
    ds_read_b64_tr_b16 v[44:45], v104 offset:46080
    ds_read_b64_tr_b16 v[46:47], v104 offset:46336
    s_waitcnt lgkmcnt(6)
    v_mfma_f32_32x32x16_bf16 v[16:31], v[36:39], v[160:163], v[16:31]
    buffer_store_dwordx4 v[108:111], v119, s[12:15], s97 offen offset:0 sc1
    v_mfma_f32_16x16x32_bf16 v[68:71], v[94:97], v[36:39], v[68:71]
    s_waitcnt lgkmcnt(5)
    v_mfma_f32_32x32x16_bf16 a[0:15], v[168:171], v[168:171], a[0:15]
    v_mfma_f32_16x16x32_bf16 v[124:127], v[94:97], v[168:171], v[124:127]
    ds_read_b64_tr_b16 v[48:49], v105 offset:4096
    ds_read_b64_tr_b16 v[50:51], v105 offset:4352
    s_waitcnt lgkmcnt(5)
    v_mfma_f32_32x32x16_bf16 v[0:15], v[40:43], v[164:167], v[0:15]
    s_add_u32 m0, s69, 26624
    s_nop 0
    buffer_load_dwordx4 v93, s[8:11], s93 offen offset:1024 lds
    v_mfma_f32_16x16x32_bf16 v[64:67], v[94:97], v[40:43], v[64:67]
    s_waitcnt lgkmcnt(4)
    v_mfma_f32_32x32x16_bf16 a[0:15], v[172:175], v[172:175], a[0:15]
    v_mfma_f32_16x16x32_bf16 v[124:127], v[94:97], v[172:175], v[124:127]
    ds_read_b64_tr_b16 v[52:53], v105 offset:5120
    ds_read_b64_tr_b16 v[54:55], v105 offset:5376
    s_waitcnt lgkmcnt(4)
    v_mfma_f32_32x32x16_bf16 v[16:31], v[44:47], v[164:167], v[16:31]
    s_add_u32 m0, s69, 4096
    s_nop 0
    buffer_load_dwordx4 v74, s[4:7], s82 offen offset:2048 lds
    v_mfma_f32_16x16x32_bf16 v[68:71], v[94:97], v[44:47], v[68:71]
    ds_read_b64_tr_b16 v[56:57], v105 offset:45056
    ds_read_b64_tr_b16 v[58:59], v105 offset:45312
    s_waitcnt lgkmcnt(4)
    v_mfma_f32_32x32x16_bf16 v[0:15], v[48:51], v[168:171], v[0:15]
    buffer_load_dwordx4 v75, s[4:7], s82 offen offset:3072 lds
    v_mfma_f32_16x16x32_bf16 v[64:67], v[94:97], v[48:51], v[64:67]
    ds_read_b64_tr_b16 v[60:61], v105 offset:46080
    ds_read_b64_tr_b16 v[62:63], v105 offset:46336
    s_waitcnt lgkmcnt(4)
    v_mfma_f32_32x32x16_bf16 v[16:31], v[52:55], v[168:171], v[16:31]
    v_mfma_f32_16x16x32_bf16 v[68:71], v[94:97], v[52:55], v[68:71]
    s_waitcnt vmcnt(14)
    s_barrier
    ds_read_b128 v[176:179], v76 offset:12288
    ds_read_b64_tr_b16 v[32:33], v104 offset:6144
    ds_read_b64_tr_b16 v[34:35], v104 offset:6400
    s_waitcnt lgkmcnt(5)
    v_mfma_f32_32x32x16_bf16 v[0:15], v[56:59], v[172:175], v[0:15]
    s_add_u32 s82, s82, 128
    s_add_u32 s93, s93, 172032
    s_cmp_eq_u32 s82, s85
    s_cselect_b32 s91, 896, 0
    s_cselect_b32 s93, 0, s93
    s_sub_u32 s82, s82, s91
    s_add_u32 m0, s69, 28672
    s_nop 0
    buffer_load_dwordx4 v92, s[8:11], s93 offen offset:0 lds
    v_mfma_f32_16x16x32_bf16 v[64:67], v[94:97], v[56:59], v[64:67]
    ds_read_b128 v[180:183], v77 offset:12288
    ds_read_b64_tr_b16 v[36:37], v104 offset:7168
    ds_read_b64_tr_b16 v[38:39], v104 offset:7424
    s_waitcnt lgkmcnt(6)
    v_mfma_f32_32x32x16_bf16 v[16:31], v[60:63], v[172:175], v[16:31]
    s_add_u32 m0, s69, 8192
    s_nop 0
    buffer_load_dwordx4 v72, s[4:7], s82 offen offset:0 lds
    v_mfma_f32_16x16x32_bf16 v[68:71], v[94:97], v[60:63], v[68:71]
    s_waitcnt lgkmcnt(5)
    v_mfma_f32_32x32x16_bf16 a[0:15], v[176:179], v[176:179], a[0:15]
    v_mfma_f32_16x16x32_bf16 v[124:127], v[94:97], v[176:179], v[124:127]
    ds_read_b128 v[184:187], v78 offset:12288
    ds_read_b64_tr_b16 v[40:41], v104 offset:47104
    ds_read_b64_tr_b16 v[42:43], v104 offset:47360
    s_waitcnt lgkmcnt(6)
    v_mfma_f32_32x32x16_bf16 v[0:15], v[32:35], v[176:179], v[0:15]
    buffer_load_dwordx4 v73, s[4:7], s82 offen offset:1024 lds
    v_mfma_f32_16x16x32_bf16 v[64:67], v[94:97], v[32:35], v[64:67]
    s_waitcnt lgkmcnt(5)
    v_mfma_f32_32x32x16_bf16 a[0:15], v[180:183], v[180:183], a[0:15]
    v_mfma_f32_16x16x32_bf16 v[124:127], v[94:97], v[180:183], v[124:127]
    ds_read_b128 v[188:191], v79 offset:12288
    ds_read_b64_tr_b16 v[44:45], v104 offset:48128
    ds_read_b64_tr_b16 v[46:47], v104 offset:48384
    s_waitcnt lgkmcnt(6)
    v_mfma_f32_32x32x16_bf16 v[16:31], v[36:39], v[176:179], v[16:31]
    buffer_store_dwordx4 v[108:111], v119, s[12:15], s97 offen offset:1024 sc1
    v_mfma_f32_16x16x32_bf16 v[68:71], v[94:97], v[36:39], v[68:71]
    s_waitcnt lgkmcnt(5)
    v_mfma_f32_32x32x16_bf16 a[0:15], v[184:187], v[184:187], a[0:15]
    v_mfma_f32_16x16x32_bf16 v[124:127], v[94:97], v[184:187], v[124:127]
    ds_read_b64_tr_b16 v[48:49], v105 offset:6144
    ds_read_b64_tr_b16 v[50:51], v105 offset:6400
    s_waitcnt lgkmcnt(5)
    v_mfma_f32_32x32x16_bf16 v[0:15], v[40:43], v[180:183], v[0:15]
    s_add_u32 m0, s69, 28672
    s_nop 0
    buffer_load_dwordx4 v93, s[8:11], s93 offen offset:1024 lds
    v_mfma_f32_16x16x32_bf16 v[64:67], v[94:97], v[40:43], v[64:67]
    s_waitcnt lgkmcnt(4)
    v_mfma_f32_32x32x16_bf16 a[0:15], v[188:191], v[188:191], a[0:15]
    v_mfma_f32_16x16x32_bf16 v[124:127], v[94:97], v[188:191], v[124:127]
    ds_read_b64_tr_b16 v[52:53], v105 offset:7168
    ds_read_b64_tr_b16 v[54:55], v105 offset:7424
    s_waitcnt lgkmcnt(4)
    v_mfma_f32_32x32x16_bf16 v[16:31], v[44:47], v[180:183], v[16:31]
    s_add_u32 m0, s69, 8192
    s_nop 0
    buffer_load_dwordx4 v74, s[4:7], s82 offen offset:2048 lds
    v_mfma_f32_16x16x32_bf16 v[68:71], v[94:97], v[44:47], v[68:71]
    ds_read_b64_tr_b16 v[56:57], v105 offset:47104
    ds_read_b64_tr_b16 v[58:59], v105 offset:47360
    s_waitcnt lgkmcnt(4)
    v_mfma_f32_32x32x16_bf16 v[0:15], v[48:51], v[184:187], v[0:15]
    buffer_load_dwordx4 v75, s[4:7], s82 offen offset:3072 lds
    v_mfma_f32_16x16x32_bf16 v[64:67], v[94:97], v[48:51], v[64:67]
    ds_read_b64_tr_b16 v[60:61], v105 offset:48128
    ds_read_b64_tr_b16 v[62:63], v105 offset:48384
    s_waitcnt lgkmcnt(4)
    v_mfma_f32_32x32x16_bf16 v[16:31], v[52:55], v[184:187], v[16:31]
    v_mfma_f32_16x16x32_bf16 v[68:71], v[94:97], v[52:55], v[68:71]
    s_waitcnt vmcnt(14)
    s_barrier
    ds_read_b128 v[192:195], v76 offset:0
    ds_read_b64_tr_b16 v[32:33], v104 offset:8192
    ds_read_b64_tr_b16 v[34:35], v104 offset:8448
    s_waitcnt lgkmcnt(5)
    v_mfma_f32_32x32x16_bf16 v[0:15], v[56:59], v[188:191], v[0:15]
    buffer_store_dwordx4 v[108:111], v119, s[12:15], s97 offen offset:2048 sc1
    v_mfma_f32_16x16x32_bf16 v[64:67], v[94:97], v[56:59], v[64:67]
    ds_read_b128 v[196:199], v77 offset:0
    ds_read_b64_tr_b16 v[36:37], v104 offset:9216
    ds_read_b64_tr_b16 v[38:39], v104 offset:9472
    s_waitcnt lgkmcnt(6)
    v_mfma_f32_32x32x16_bf16 v[16:31], v[60:63], v[188:191], v[16:31]
    buffer_store_dwordx4 v[108:111], v119, s[12:15], s97 offen offset:3072 sc1
    v_mfma_f32_16x16x32_bf16 v[68:71], v[94:97], v[60:63], v[68:71]
    s_waitcnt lgkmcnt(5)
    v_mfma_f32_32x32x16_bf16 a[0:15], v[192:195], v[192:195], a[0:15]
    v_mfma_f32_16x16x32_bf16 v[124:127], v[94:97], v[192:195], v[124:127]
    ds_read_b128 v[200:203], v78 offset:0
    ds_read_b64_tr_b16 v[40:41], v104 offset:49152
    ds_read_b64_tr_b16 v[42:43], v104 offset:49408
    s_waitcnt lgkmcnt(6)
    v_mfma_f32_32x32x16_bf16 v[0:15], v[32:35], v[192:195], v[0:15]
    v_mfma_f32_16x16x32_bf16 v[64:67], v[94:97], v[32:35], v[64:67]
    s_waitcnt lgkmcnt(5)
    v_mfma_f32_32x32x16_bf16 a[0:15], v[196:199], v[196:199], a[0:15]
    v_mfma_f32_16x16x32_bf16 v[124:127], v[94:97], v[196:199], v[124:127]
    ds_read_b128 v[204:207], v79 offset:0
    ds_read_b64_tr_b16 v[44:45], v104 offset:50176
    ds_read_b64_tr_b16 v[46:47], v104 offset:50432
    s_waitcnt lgkmcnt(6)
    v_mfma_f32_32x32x16_bf16 v[16:31], v[36:39], v[192:195], v[16:31]
    v_mfma_f32_16x16x32_bf16 v[68:71], v[94:97], v[36:39], v[68:71]
    s_waitcnt lgkmcnt(5)
    v_mfma_f32_32x32x16_bf16 a[0:15], v[200:203], v[200:203], a[0:15]
    v_mfma_f32_16x16x32_bf16 v[124:127], v[94:97], v[200:203], v[124:127]
    ds_read_b64_tr_b16 v[48:49], v105 offset:8192
    ds_read_b64_tr_b16 v[50:51], v105 offset:8448
    s_waitcnt lgkmcnt(5)
    v_mfma_f32_32x32x16_bf16 v[0:15], v[40:43], v[196:199], v[0:15]
    v_mfma_f32_16x16x32_bf16 v[64:67], v[94:97], v[40:43], v[64:67]
    s_waitcnt lgkmcnt(4)
    v_mfma_f32_32x32x16_bf16 a[0:15], v[204:207], v[204:207], a[0:15]
    v_mfma_f32_16x16x32_bf16 v[124:127], v[94:97], v[204:207], v[124:127]
    ds_read_b64_tr_b16 v[52:53], v105 offset:9216
    ds_read_b64_tr_b16 v[54:55], v105 offset:9472
    s_waitcnt lgkmcnt(4)
    v_mfma_f32_32x32x16_bf16 v[16:31], v[44:47], v[196:199], v[16:31]
    v_mfma_f32_16x16x32_bf16 v[68:71], v[94:97], v[44:47], v[68:71]
    ds_read_b64_tr_b16 v[56:57], v105 offset:49152
    ds_read_b64_tr_b16 v[58:59], v105 offset:49408
    s_waitcnt lgkmcnt(4)
    v_mfma_f32_32x32x16_bf16 v[0:15], v[48:51], v[200:203], v[0:15]
    v_mfma_f32_16x16x32_bf16 v[64:67], v[94:97], v[48:51], v[64:67]
    ds_read_b64_tr_b16 v[60:61], v105 offset:50176
    ds_read_b64_tr_b16 v[62:63], v105 offset:50432
    s_waitcnt lgkmcnt(4)
    v_mfma_f32_32x32x16_bf16 v[16:31], v[52:55], v[200:203], v[16:31]
    v_mfma_f32_16x16x32_bf16 v[68:71], v[94:97], v[52:55], v[68:71]
    s_waitcnt vmcnt(9)
    s_barrier
    ds_read_b128 v[208:211], v76 offset:4096
    ds_read_b64_tr_b16 v[32:33], v104 offset:10240
    ds_read_b64_tr_b16 v[34:35], v104 offset:10496
    s_waitcnt lgkmcnt(5)
    v_mfma_f32_32x32x16_bf16 v[0:15], v[56:59], v[204:207], v[0:15]
    s_add_u32 s97, s97, 4096
    buffer_store_dwordx4 v[108:111], v119, s[12:15], s97 offen offset:0 sc1
    v_mfma_f32_16x16x32_bf16 v[64:67], v[94:97], v[56:59], v[64:67]
    ds_read_b128 v[212:215], v77 offset:4096
    ds_read_b64_tr_b16 v[36:37], v104 offset:11264
    ds_read_b64_tr_b16 v[38:39], v104 offset:11520
    s_waitcnt lgkmcnt(6)
    v_mfma_f32_32x32x16_bf16 v[16:31], v[60:63], v[204:207], v[16:31]
    buffer_store_dwordx4 v[108:111], v119, s[12:15], s97 offen offset:1024 sc1
    v_mfma_f32_16x16x32_bf16 v[68:71], v[94:97], v[60:63], v[68:71]
    s_waitcnt lgkmcnt(5)
    v_mfma_f32_32x32x16_bf16 a[0:15], v[208:211], v[208:211], a[0:15]
    v_mfma_f32_16x16x32_bf16 v[124:127], v[94:97], v[208:211], v[124:127]
    ds_read_b128 v[216:219], v78 offset:4096
    ds_read_b64_tr_b16 v[40:41], v104 offset:51200
    ds_read_b64_tr_b16 v[42:43], v104 offset:51456
    s_waitcnt lgkmcnt(6)
    v_mfma_f32_32x32x16_bf16 v[0:15], v[32:35], v[208:211], v[0:15]
    v_mfma_f32_16x16x32_bf16 v[64:67], v[94:97], v[32:35], v[64:67]
    s_waitcnt lgkmcnt(5)
    v_mfma_f32_32x32x16_bf16 a[0:15], v[212:215], v[212:215], a[0:15]
    v_mfma_f32_16x16x32_bf16 v[124:127], v[94:97], v[212:215], v[124:127]
    ds_read_b128 v[220:223], v79 offset:4096
    ds_read_b64_tr_b16 v[44:45], v104 offset:52224
    ds_read_b64_tr_b16 v[46:47], v104 offset:52480
    s_waitcnt lgkmcnt(6)
    v_mfma_f32_32x32x16_bf16 v[16:31], v[36:39], v[208:211], v[16:31]
    v_mfma_f32_16x16x32_bf16 v[68:71], v[94:97], v[36:39], v[68:71]
    s_waitcnt lgkmcnt(5)
    v_mfma_f32_32x32x16_bf16 a[0:15], v[216:219], v[216:219], a[0:15]
    v_mfma_f32_16x16x32_bf16 v[124:127], v[94:97], v[216:219], v[124:127]
    ds_read_b64_tr_b16 v[48:49], v105 offset:10240
    ds_read_b64_tr_b16 v[50:51], v105 offset:10496
    s_waitcnt lgkmcnt(5)
    v_mfma_f32_32x32x16_bf16 v[0:15], v[40:43], v[212:215], v[0:15]
    v_mfma_f32_16x16x32_bf16 v[64:67], v[94:97], v[40:43], v[64:67]
    s_waitcnt lgkmcnt(4)
    v_mfma_f32_32x32x16_bf16 a[0:15], v[220:223], v[220:223], a[0:15]
    v_mfma_f32_16x16x32_bf16 v[124:127], v[94:97], v[220:223], v[124:127]
    ds_read_b64_tr_b16 v[52:53], v105 offset:11264
    ds_read_b64_tr_b16 v[54:55], v105 offset:11520
    s_waitcnt lgkmcnt(4)
    v_mfma_f32_32x32x16_bf16 v[16:31], v[44:47], v[212:215], v[16:31]
    v_mfma_f32_16x16x32_bf16 v[68:71], v[94:97], v[44:47], v[68:71]
    ds_read_b64_tr_b16 v[56:57], v105 offset:51200
    ds_read_b64_tr_b16 v[58:59], v105 offset:51456
    s_waitcnt lgkmcnt(4)
    v_mfma_f32_32x32x16_bf16 v[0:15], v[48:51], v[216:219], v[0:15]
    v_mfma_f32_16x16x32_bf16 v[64:67], v[94:97], v[48:51], v[64:67]
    ds_read_b64_tr_b16 v[60:61], v105 offset:52224
    ds_read_b64_tr_b16 v[62:63], v105 offset:52480
    s_waitcnt lgkmcnt(4)
    v_mfma_f32_32x32x16_bf16 v[16:31], v[52:55], v[216:219], v[16:31]
    v_mfma_f32_16x16x32_bf16 v[68:71], v[94:97], v[52:55], v[68:71]
    s_waitcnt vmcnt(4)
    s_barrier
    s_mov_b32 s93, 65536
    buffer_load_dwordx2 a[254:255], v107, s[12:15], s93 offen sc1
    ds_read_b128 v[224:227], v76 offset:8192
    ds_read_b64_tr_b16 v[32:33], v104 offset:12288
    ds_read_b64_tr_b16 v[34:35], v104 offset:12544
    s_waitcnt lgkmcnt(5)
    v_mfma_f32_32x32x16_bf16 v[0:15], v[56:59], v[220:223], v[0:15]
    buffer_store_dwordx4 v[108:111], v119, s[12:15], s97 offen offset:2048 sc1
    v_mfma_f32_16x16x32_bf16 v[64:67], v[94:97], v[56:59], v[64:67]
    ds_read_b128 v[228:231], v77 offset:8192
    ds_read_b64_tr_b16 v[36:37], v104 offset:13312
    ds_read_b64_tr_b16 v[38:39], v104 offset:13568
    s_waitcnt lgkmcnt(6)
    v_mfma_f32_32x32x16_bf16 v[16:31], v[60:63], v[220:223], v[16:31]
    buffer_store_dwordx4 v[108:111], v119, s[12:15], s97 offen offset:3072 sc1
    v_mfma_f32_16x16x32_bf16 v[68:71], v[94:97], v[60:63], v[68:71]
    s_waitcnt lgkmcnt(5)
    v_mfma_f32_32x32x16_bf16 a[0:15], v[224:227], v[224:227], a[0:15]
    v_mfma_f32_16x16x32_bf16 v[124:127], v[94:97], v[224:227], v[124:127]
    ds_read_b128 v[232:235], v78 offset:8192
    ds_read_b64_tr_b16 v[40:41], v104 offset:53248
    ds_read_b64_tr_b16 v[42:43], v104 offset:53504
    s_waitcnt lgkmcnt(6)
    v_mfma_f32_32x32x16_bf16 v[0:15], v[32:35], v[224:227], v[0:15]
    s_add_u32 s97, s97, 4096
    buffer_store_dwordx4 v[108:111], v119, s[12:15], s97 offen offset:0 sc1
    v_mfma_f32_16x16x32_bf16 v[64:67], v[94:97], v[32:35], v[64:67]
    s_waitcnt lgkmcnt(5)
    v_mfma_f32_32x32x16_bf16 a[0:15], v[228:231], v[228:231], a[0:15]
    v_mfma_f32_16x16x32_bf16 v[124:127], v[94:97], v[228:231], v[124:127]
    ds_read_b128 v[236:239], v79 offset:8192
    ds_read_b64_tr_b16 v[44:45], v104 offset:54272
    ds_read_b64_tr_b16 v[46:47], v104 offset:54528
    s_waitcnt lgkmcnt(6)
    v_mfma_f32_32x32x16_bf16 v[16:31], v[36:39], v[224:227], v[16:31]
    s_add_u32 s21, s81, 0
    s_and_b32 s21, s21, s23
    s_lshr_b32 s63, s21, 1
    s_mul_i32 s63, s63, s24
    s_add_u32 s21, s21, s63
    s_mul_i32 s21, s21, s20
    s_add_u32 s21, s21, s86
    s_add_u32 m0, s69, 32768
    s_nop 0
    buffer_load_dwordx4 v84, s[40:43], s21 offen offset:0 lds
    v_mfma_f32_16x16x32_bf16 v[68:71], v[94:97], v[36:39], v[68:71]
    s_waitcnt lgkmcnt(5)
    v_mfma_f32_32x32x16_bf16 a[0:15], v[232:235], v[232:235], a[0:15]
    v_mfma_f32_16x16x32_bf16 v[124:127], v[94:97], v[232:235], v[124:127]
    ds_read_b64_tr_b16 v[48:49], v105 offset:12288
    ds_read_b64_tr_b16 v[50:51], v105 offset:12544
    s_waitcnt lgkmcnt(5)
    v_mfma_f32_32x32x16_bf16 v[0:15], v[40:43], v[228:231], v[0:15]
    buffer_load_dwordx4 v85, s[40:43], s21 offen offset:1024 lds
    v_mfma_f32_16x16x32_bf16 v[64:67], v[94:97], v[40:43], v[64:67]
    s_waitcnt lgkmcnt(4)
    v_mfma_f32_32x32x16_bf16 a[0:15], v[236:239], v[236:239], a[0:15]
    v_mfma_f32_16x16x32_bf16 v[124:127], v[94:97], v[236:239], v[124:127]
    ds_read_b64_tr_b16 v[52:53], v105 offset:13312
    ds_read_b64_tr_b16 v[54:55], v105 offset:13568
    s_waitcnt lgkmcnt(4)
    v_mfma_f32_32x32x16_bf16 v[16:31], v[44:47], v[228:231], v[16:31]
    buffer_load_dwordx4 v86, s[40:43], s21 offen offset:2048 lds
    v_mfma_f32_16x16x32_bf16 v[68:71], v[94:97], v[44:47], v[68:71]
    ds_read_b64_tr_b16 v[56:57], v105 offset:53248
    ds_read_b64_tr_b16 v[58:59], v105 offset:53504
    s_waitcnt lgkmcnt(4)
    v_mfma_f32_32x32x16_bf16 v[0:15], v[48:51], v[232:235], v[0:15]
    buffer_load_dwordx4 v87, s[40:43], s21 offen offset:3072 lds
    v_mfma_f32_16x16x32_bf16 v[64:67], v[94:97], v[48:51], v[64:67]
    ds_read_b64_tr_b16 v[60:61], v105 offset:54272
    ds_read_b64_tr_b16 v[62:63], v105 offset:54528
    s_waitcnt lgkmcnt(4)
    v_mfma_f32_32x32x16_bf16 v[16:31], v[52:55], v[232:235], v[16:31]
    v_mfma_f32_16x16x32_bf16 v[68:71], v[94:97], v[52:55], v[68:71]
    s_mov_b32 vcc_lo, 0xaaaaaaaa
    s_mov_b32 vcc_hi, 0xaaaaaaaa
    v_accvgpr_read_b32 v72, a0
    v_accvgpr_read_b32 v242, a1
    v_cndmask_b32 v72, v72, v242, vcc
    v_accvgpr_read_b32 v73, a2
    v_accvgpr_read_b32 v242, a3
    v_cndmask_b32 v73, v73, v242, vcc
    s_waitcnt lgkmcnt(2)
    v_mfma_f32_32x32x16_bf16 v[0:15], v[56:59], v[236:239], v[0:15]
    v_mfma_f32_16x16x32_bf16 v[64:67], v[94:97], v[56:59], v[64:67]
    v_accvgpr_read_b32 v74, a4
    v_accvgpr_read_b32 v242, a5
    v_cndmask_b32 v74, v74, v242, vcc
    v_accvgpr_read_b32 v75, a6
    v_accvgpr_read_b32 v242, a7
    v_cndmask_b32 v75, v75, v242, vcc
    v_accvgpr_read_b32 v76, a8
    v_accvgpr_read_b32 v242, a9
    s_waitcnt lgkmcnt(0)
    v_mfma_f32_32x32x16_bf16 v[16:31], v[60:63], v[236:239], v[16:31]
    v_mfma_f32_16x16x32_bf16 v[68:71], v[94:97], v[60:63], v[68:71]
    v_cndmask_b32 v76, v76, v242, vcc
    v_accvgpr_read_b32 v77, a10
    v_accvgpr_read_b32 v242, a11
    v_cndmask_b32 v77, v77, v242, vcc
    v_accvgpr_read_b32 v78, a12
    v_accvgpr_read_b32 v242, a13
    v_cndmask_b32 v78, v78, v242, vcc
    v_accvgpr_read_b32 v79, a14
    v_accvgpr_read_b32 v242, a15
    v_cndmask_b32 v79, v79, v242, vcc
    s_mov_b32 vcc_lo, 0xcccccccc
    s_mov_b32 vcc_hi, 0xcccccccc
    v_cndmask_b32 v72, v72, v73, vcc
    v_cndmask_b32 v74, v74, v75, vcc
    v_cndmask_b32 v76, v76, v77, vcc
    v_cndmask_b32 v78, v78, v79, vcc
    s_mov_b32 vcc_lo, 0xff00ff00
    s_mov_b32 vcc_hi, 0xff00ff00
    v_cndmask_b32 v72, v72, v74, vcc
    v_cndmask_b32 v76, v76, v78, vcc
    s_mov_b32 vcc_lo, 0xffff0000
    s_mov_b32 vcc_hi, 0xffff0000
    v_cndmask_b32 v72, v72, v76, vcc
    s_mov_b32 vcc_lo, 0xf0f0f0f
    s_mov_b32 vcc_hi, 0xf0f0f0f0
    v_cndmask_b32 v80, 0, v72, vcc
    v_cndmask_b32 v83, 0, v72, vcc
    v_mul_f32 v103, 0x3b124925, v124
    s_nop 0
    v_permlane32_swap_b32 v83, v80
    v_add_f32 v80, v80, v83
    v_mul_f32 v242, v103, v103
    v_mov_b32 v243, 0x3b124925
    v_fma_f32 v242, v80, v243, -v242
    v_cvt_pk_bf16_f32 v80, -v103, -v103
    v_max_f32 v242, 0, v242
    v_lshlrev_b32 v243, 16, v80
    v_add_f32 v242, 0x3727c5ac, v242
    v_add_f32 v243, v103, v243
    v_rsq_f32 v83, v242
    v_cvt_pk_bf16_f32 v81, -v243, 0
    v_cndmask_b32 v80, 0, v80, s[60:61]
    v_cndmask_b32 v81, 0, v81, s[60:61]
    v_mov_b32 v82, 0
    v_mul_f32 v102, 0x3fb8aa3b, v83
    v_lshl_add_u32 v242, v249, 2, v248
    v_min_u32 v242, 6, v242
    v_lshlrev_b32 v242, 3, v242
    v_mov_b32 v243, 224
    v_mad_u32_u24 v242, v246, v243, v242
    v_mad_u32_u24 v242, v247, 56, v242
    ds_read_b64_tr_b16 v[92:93], v242 offset:30720
    ds_read_b64_tr_b16 v[94:95], v242 offset:31168
    ds_read_b64_tr_b16 v[96:97], v242 offset:31616
    ds_read_b64_tr_b16 v[98:99], v242 offset:32064
    v_mov_b32 v104, v83
    v_mov_b32 v83, 0
    v_cvt_pk_bf16_f32 v73, v64, 0
    v_lshlrev_b32 v242, 16, v73
    v_sub_f32 v242, v64, v242
    v_cvt_pk_bf16_f32 v72, v64, v242
    v_mov_b32 v74, 0
    v_mov_b32 v75, 0
    s_nop 1
    v_mfma_f32_32x32x16_bf16 v[0:15], v[72:75], v[80:83], v[0:15]
    v_cvt_pk_bf16_f32 v77, v68, 0
    v_lshlrev_b32 v242, 16, v77
    v_sub_f32 v242, v68, v242
    v_cvt_pk_bf16_f32 v76, v68, v242
    v_mov_b32 v78, 0
    v_mov_b32 v79, 0
    s_nop 1
    v_mfma_f32_32x32x16_bf16 v[16:31], v[76:79], v[80:83], v[16:31]
    s_waitcnt lgkmcnt(0)
    s_waitcnt vmcnt(4)
    s_barrier
    s_cmp_lg_u32 s66, 0
    s_cbranch_scc1 NOFC
    s_lshl_b32 s3, s2, 2
    s_add_u32 s3, s3, 131072
    buffer_store_dword v251, v252, s[12:15], s3 offen sc1
NOFC:
    s_cmp_lt_u32 s71, 28
    s_cselect_b64 vcc, -1, 0
    v_pk_mul_f32 v[0:1], v[0:1], v[102:103] op_sel_hi:[1,0]
    v_pk_mul_f32 v[2:3], v[2:3], v[102:103] op_sel_hi:[1,0]
    v_pk_mul_f32 v[4:5], v[4:5], v[102:103] op_sel_hi:[1,0]
    v_pk_mul_f32 v[6:7], v[6:7], v[102:103] op_sel_hi:[1,0]
    v_pk_mul_f32 v[8:9], v[8:9], v[102:103] op_sel_hi:[1,0]
    v_pk_mul_f32 v[10:11], v[10:11], v[102:103] op_sel_hi:[1,0]
    v_pk_mul_f32 v[12:13], v[12:13], v[102:103] op_sel_hi:[1,0]
    v_pk_mul_f32 v[14:15], v[14:15], v[102:103] op_sel_hi:[1,0]
    v_cvt_pk_bf16_f32 v64, v0, v1
    v_cvt_pk_bf16_f32 v65, v2, v3
    v_cvt_pk_bf16_f32 v66, v4, v5
    v_cvt_pk_bf16_f32 v67, v6, v7
    v_cvt_pk_bf16_f32 v68, v8, v9
    v_cvt_pk_bf16_f32 v69, v10, v11
    v_cvt_pk_bf16_f32 v70, v12, v13
    v_cvt_pk_bf16_f32 v71, v14, v15
    v_cndmask_b32 v70, v70, 0, s[60:61]
    v_cndmask_b32 v71, v71, 0, s[60:61]
    v_cndmask_b32 v98, v98, 0, s[60:61]
    v_cndmask_b32 v99, v99, 0, s[60:61]
    v_mfma_f32_32x32x16_bf16 v[0:15], v[92:95], v[64:67], 0
    s_nop 0
    v_mfma_f32_32x32x16_bf16 v[0:15], v[96:99], v[68:71], v[0:15]
    s_mov_b32 s84, 40000
    v_accvgpr_read_b32 v242, a254
    v_accvgpr_read_b32 v243, a255
    v_xor_b32 v242, s67, v242
    v_bitop3_b32 v242, s67, v243, v242 bitop3:0xbe
    v_cmp_ne_u32 vcc, 0, v242
    s_cbranch_vccnz P0S
P0R:
    s_cmp_lt_u32 s71, 28
    s_cselect_b64 vcc, -1, 0
    s_add_u32 m0, s69, 16384
    s_nop 0
    buffer_load_dwordx4 v250, s[12:15], s25 offen offset:0 sc1 lds
    buffer_load_dwordx4 v250, s[12:15], s26 offen offset:1024 sc1 lds
    buffer_load_dwordx4 v250, s[12:15], s27 offen offset:2048 sc1 lds
    buffer_load_dwordx4 v250, s[12:15], s28 offen offset:3072 sc1 lds
    s_add_u32 m0, s69, 20480
    s_nop 0
    buffer_load_dwordx4 v250, s[12:15], s29 offen offset:0 sc1 lds
    buffer_load_dwordx4 v250, s[12:15], s30 offen offset:1024 sc1 lds
    buffer_load_dwordx4 v250, s[12:15], s31 offen offset:2048 sc1 lds
    s_mul_i32 s21, s22, -1
    s_add_u32 s21, s21, s81
    s_add_u32 s21, s21, 1
    s_and_b32 s21, s21, s23
    s_lshr_b32 s63, s21, 1
    s_mul_i32 s63, s63, s24
    s_add_u32 s21, s21, s63
    s_lshl_b32 s63, s22, 5
    s_add_u32 s21, s21, s63
    s_mul_i32 s21, s21, s20
    s_add_u32 s21, s21, s86
    s_add_u32 m0, s69, 36864
    s_nop 0
    buffer_load_dwordx4 v84, s[40:43], s21 offen offset:0 lds
    v_mul_f32 v16, v16, v104
    v_mul_f32 v17, v17, v104
    v_mul_f32 v18, v18, v104
    v_mul_f32 v19, v19, v104
    v_mul_f32 v20, v20, v104
    v_mul_f32 v21, v21, v104
    v_mul_f32 v22, v22, v104
    v_mul_f32 v23, v23, v104
    v_mul_f32 v24, v24, v104
    v_mul_f32 v25, v25, v104
    v_mul_f32 v26, v26, v104
    v_mul_f32 v27, v27, v104
    v_mul_f32 v28, v28, v104
    v_mul_f32 v29, v29, v104
    v_mul_f32 v30, v30, v104
    v_mul_f32 v31, v31, v104
    buffer_load_dwordx4 v85, s[40:43], s21 offen offset:1024 lds
    v_cvt_pk_bf16_f32 v48, v16, v17
    v_cvt_pk_bf16_f32 v49, v18, v19
    v_cvt_pk_bf16_f32 v50, v20, v21
    v_cvt_pk_bf16_f32 v51, v22, v23
    v_cvt_pk_bf16_f32 v52, v24, v25
    v_cvt_pk_bf16_f32 v53, v26, v27
    v_cvt_pk_bf16_f32 v54, v28, v29
    v_cvt_pk_bf16_f32 v55, v30, v31
    v_mov_b32 v244, 0x3f80
    v_cndmask_b32 v54, v54, v244, s[60:61]
    v_cndmask_b32 v55, v55, 0, s[60:61]
    ds_write_b64 v113, v[48:49] offset:4352
    ds_write_b64 v113, v[50:51] offset:4368
    ds_write_b64 v113, v[52:53] offset:4384
    ds_write_b64 v113, v[54:55] offset:4400
    v_max3_f32 v126, v0, v1, v2
    v_min3_f32 v90, v0, v1, v2
    v_max3_f32 v127, v3, v4, v5
    v_min3_f32 v91, v3, v4, v5
    v_max3_f32 v126, v126, v6, v7
    v_min3_f32 v90, v90, v6, v7
    v_max3_f32 v127, v127, v8, v9
    v_min3_f32 v91, v91, v8, v9
    v_max3_f32 v126, v126, v10, v11
    v_min3_f32 v90, v90, v10, v11
    v_max3_f32 v127, v127, v12, v13
    v_min3_f32 v91, v91, v12, v13
    v_max3_f32 v126, v126, v14, v15
    v_min3_f32 v90, v90, v14, v15
    v_max_f32 v126, v126, v127
    v_min_f32 v90, v90, v91
    v_mov_b32 v127, v126
    v_mov_b32 v91, v90
    buffer_load_dwordx4 v86, s[40:43], s21 offen offset:2048 lds
    v_permlane32_swap_b32 v126, v127
    v_permlane32_swap_b32 v90, v91
    v_max_f32 v126, v126, v127
    v_min_f32 v90, v90, v91
    v_pk_add_f32 v[16:17], v[0:1], v[126:127] op_sel_hi:[1,0] neg_lo:[0,1] neg_hi:[0,1]
    v_pk_add_f32 v[18:19], v[2:3], v[126:127] op_sel_hi:[1,0] neg_lo:[0,1] neg_hi:[0,1]
    v_pk_add_f32 v[20:21], v[4:5], v[126:127] op_sel_hi:[1,0] neg_lo:[0,1] neg_hi:[0,1]
    v_pk_add_f32 v[22:23], v[6:7], v[126:127] op_sel_hi:[1,0] neg_lo:[0,1] neg_hi:[0,1]
    v_pk_add_f32 v[24:25], v[8:9], v[126:127] op_sel_hi:[1,0] neg_lo:[0,1] neg_hi:[0,1]
    v_pk_add_f32 v[26:27], v[10:11], v[126:127] op_sel_hi:[1,0] neg_lo:[0,1] neg_hi:[0,1]
    v_pk_add_f32 v[28:29], v[12:13], v[126:127] op_sel_hi:[1,0] neg_lo:[0,1] neg_hi:[0,1]
    v_pk_add_f32 v[30:31], v[14:15], v[126:127] op_sel_hi:[1,0] neg_lo:[0,1] neg_hi:[0,1]
    v_pk_add_f32 v[0:1], v[0:1], v[90:91] op_sel_hi:[1,0] neg_lo:[1,0] neg_hi:[1,0]
    v_pk_add_f32 v[2:3], v[2:3], v[90:91] op_sel_hi:[1,0] neg_lo:[1,0] neg_hi:[1,0]
    v_pk_add_f32 v[4:5], v[4:5], v[90:91] op_sel_hi:[1,0] neg_lo:[1,0] neg_hi:[1,0]
    v_pk_add_f32 v[6:7], v[6:7], v[90:91] op_sel_hi:[1,0] neg_lo:[1,0] neg_hi:[1,0]
    v_pk_add_f32 v[8:9], v[8:9], v[90:91] op_sel_hi:[1,0] neg_lo:[1,0] neg_hi:[1,0]
    v_pk_add_f32 v[10:11], v[10:11], v[90:91] op_sel_hi:[1,0] neg_lo:[1,0] neg_hi:[1,0]
    v_pk_add_f32 v[12:13], v[12:13], v[90:91] op_sel_hi:[1,0] neg_lo:[1,0] neg_hi:[1,0]
    v_pk_add_f32 v[14:15], v[14:15], v[90:91] op_sel_hi:[1,0] neg_lo:[1,0] neg_hi:[1,0]
    buffer_load_dwordx4 v87, s[40:43], s21 offen offset:3072 lds
    v_exp_f32 v16, v16
    v_exp_f32 v17, v17
    v_exp_f32 v18, v18
    v_exp_f32 v19, v19
    v_exp_f32 v20, v20
    v_exp_f32 v21, v21
    v_exp_f32 v22, v22
    v_exp_f32 v23, v23
    s_mul_i32 s21, s22, -1
    s_add_u32 s21, s21, s81
    s_add_u32 s21, s21, 2
    s_and_b32 s21, s21, s23
    s_lshr_b32 s63, s21, 1
    s_mul_i32 s63, s63, s24
    s_add_u32 s21, s21, s63
    s_mul_i32 s21, s21, s20
    s_add_u32 s21, s21, s86
    s_add_u32 m0, s69, 12288
    s_nop 0
    buffer_load_dwordx4 v84, s[40:43], s21 offen offset:0 lds
    v_exp_f32 v24, v24
    v_exp_f32 v25, v25
    v_exp_f32 v26, v26
    v_exp_f32 v27, v27
    v_exp_f32 v28, v28
    v_exp_f32 v29, v29
    v_exp_f32 v30, v30
    v_exp_f32 v31, v31
    buffer_load_dwordx4 v85, s[40:43], s21 offen offset:1024 lds
    v_exp_f32 v0, v0
    v_exp_f32 v1, v1
    v_exp_f32 v2, v2
    v_exp_f32 v3, v3
    v_exp_f32 v4, v4
    v_exp_f32 v5, v5
    v_exp_f32 v6, v6
    v_exp_f32 v7, v7
    buffer_load_dwordx4 v86, s[40:43], s21 offen offset:2048 lds
    v_exp_f32 v8, v8
    v_exp_f32 v9, v9
    v_exp_f32 v10, v10
    v_exp_f32 v11, v11
    v_exp_f32 v12, v12
    v_exp_f32 v13, v13
    v_exp_f32 v14, v14
    v_exp_f32 v15, v15
    buffer_load_dwordx4 v87, s[40:43], s21 offen offset:3072 lds
    v_pk_add_f32 v[72:73], v[16:17], v[18:19]
    v_pk_add_f32 v[74:75], v[28:29], v[30:31]
    v_pk_add_f32 v[76:77], v[0:1], v[2:3]
    v_pk_add_f32 v[78:79], v[12:13], v[14:15]
    v_pk_add_f32 v[72:73], v[72:73], v[20:21]
    v_pk_add_f32 v[76:77], v[76:77], v[4:5]
    v_pk_add_f32 v[72:73], v[72:73], v[22:23]
    v_pk_add_f32 v[76:77], v[76:77], v[6:7]
    v_pk_add_f32 v[72:73], v[72:73], v[24:25]
    v_pk_add_f32 v[76:77], v[76:77], v[8:9]
    v_pk_add_f32 v[72:73], v[72:73], v[26:27]
    v_pk_add_f32 v[76:77], v[76:77], v[10:11]
    v_pk_fma_f32 v[72:73], v[74:75], v[106:107], v[72:73] op_sel_hi:[1,0,1]
    v_pk_fma_f32 v[76:77], v[78:79], v[106:107], v[76:77] op_sel_hi:[1,0,1]
    v_add_f32 v72, v72, v73
    v_add_f32 v76, v76, v77
    v_mov_b32 v73, v72
    v_mov_b32 v77, v76
    s_mul_i32 s21, s22, -2
    s_add_u32 s21, s21, s81
    s_add_u32 s21, s21, 3
    s_and_b32 s21, s21, s23
    s_lshr_b32 s63, s21, 1
    s_mul_i32 s63, s63, s24
    s_add_u32 s21, s21, s63
    s_lshl_b32 s63, s22, 5
    s_add_u32 s21, s21, s63
    s_mul_i32 s21, s21, s20
    s_add_u32 s21, s21, s86
    s_add_u32 m0, s69, 8192
    s_nop 0
    buffer_load_dwordx4 v84, s[40:43], s21 offen offset:0 lds
    v_permlane32_swap_b32 v72, v73
    v_permlane32_swap_b32 v76, v77
    v_add_f32 v72, v72, v73
    v_add_f32 v76, v76, v77
    v_rcp_f32 v72, v72
    v_rcp_f32 v76, v76
    v_pk_mul_f32 v[16:17], v[16:17], v[72:73] op_sel_hi:[1,0]
    v_pk_mul_f32 v[18:19], v[18:19], v[72:73] op_sel_hi:[1,0]
    v_pk_mul_f32 v[20:21], v[20:21], v[72:73] op_sel_hi:[1,0]
    v_pk_mul_f32 v[22:23], v[22:23], v[72:73] op_sel_hi:[1,0]
    v_pk_mul_f32 v[24:25], v[24:25], v[72:73] op_sel_hi:[1,0]
    v_pk_mul_f32 v[26:27], v[26:27], v[72:73] op_sel_hi:[1,0]
    v_pk_mul_f32 v[28:29], v[28:29], v[72:73] op_sel_hi:[1,0]
    v_pk_mul_f32 v[30:31], v[30:31], v[72:73] op_sel_hi:[1,0]
    v_cvt_pk_bf16_f32 v32, v16, v17
    v_cvt_pk_bf16_f32 v33, v18, v19
    v_cvt_pk_bf16_f32 v34, v20, v21
    v_cvt_pk_bf16_f32 v35, v22, v23
    v_cvt_pk_bf16_f32 v36, v24, v25
    v_cvt_pk_bf16_f32 v37, v26, v27
    v_cvt_pk_bf16_f32 v38, v28, v29
    v_cvt_pk_bf16_f32 v39, v30, v31
    buffer_load_dwordx4 v85, s[40:43], s21 offen offset:1024 lds
    v_pk_mul_f32 v[0:1], v[0:1], v[76:77] op_sel_hi:[1,0]
    v_pk_mul_f32 v[2:3], v[2:3], v[76:77] op_sel_hi:[1,0]
    v_pk_mul_f32 v[4:5], v[4:5], v[76:77] op_sel_hi:[1,0]
    v_pk_mul_f32 v[6:7], v[6:7], v[76:77] op_sel_hi:[1,0]
    v_pk_mul_f32 v[8:9], v[8:9], v[76:77] op_sel_hi:[1,0]
    v_pk_mul_f32 v[10:11], v[10:11], v[76:77] op_sel_hi:[1,0]
    v_pk_mul_f32 v[12:13], v[12:13], v[76:77] op_sel_hi:[1,0]
    v_pk_mul_f32 v[14:15], v[14:15], v[76:77] op_sel_hi:[1,0]
    v_cvt_pk_bf16_f32 v40, v0, v1
    v_cvt_pk_bf16_f32 v41, v2, v3
    v_cvt_pk_bf16_f32 v42, v4, v5
    v_cvt_pk_bf16_f32 v43, v6, v7
    v_cvt_pk_bf16_f32 v44, v8, v9
    v_cvt_pk_bf16_f32 v45, v10, v11
    v_cvt_pk_bf16_f32 v46, v12, v13
    v_cvt_pk_bf16_f32 v47, v14, v15
    buffer_load_dwordx4 v86, s[40:43], s21 offen offset:2048 lds
    ds_write_b64 v112, v[32:33] offset:0
    ds_write_b64 v112, v[34:35] offset:16
    ds_write_b64 v112, v[36:37] offset:32
    ds_write_b64 v112, v[38:39] offset:48
    ds_write_b64 v112, v[40:41] offset:64
    ds_write_b64 v112, v[42:43] offset:80
    ds_write_b64 v112, v[44:45] offset:96
    ds_write_b64 v112, v[46:47] offset:112
    s_waitcnt vmcnt(11)
    s_waitcnt lgkmcnt(0)
    s_barrier
    ds_read_b64_tr_b16 v[0:1], v114 offset:0
    ds_read_b64_tr_b16 v[2:3], v114 offset:544
    ds_read_b64_tr_b16 v[16:17], v116 offset:4352
    ds_read_b64_tr_b16 v[18:19], v116 offset:4640
    ds_read_b64_tr_b16 v[32:33], v116 offset:4384
    ds_read_b64_tr_b16 v[34:35], v116 offset:4672
    ds_read_b64_tr_b16 v[4:5], v114 offset:40960
    ds_read_b64_tr_b16 v[6:7], v114 offset:41504
    ds_read_b64_tr_b16 v[20:21], v116 offset:45312
    ds_read_b64_tr_b16 v[22:23], v116 offset:45600
    ds_read_b64_tr_b16 v[36:37], v116 offset:45344
    ds_read_b64_tr_b16 v[38:39], v116 offset:45632
    ds_read_b64_tr_b16 v[8:9], v115 offset:0
    ds_read_b64_tr_b16 v[10:11], v115 offset:544
    ds_read_b64_tr_b16 v[24:25], v117 offset:4352
    ds_read_b64_tr_b16 v[26:27], v117 offset:4640
    ds_read_b64_tr_b16 v[40:41], v117 offset:4384
    ds_read_b64_tr_b16 v[42:43], v117 offset:4672
    ds_read_b64_tr_b16 v[12:13], v115 offset:40960
    ds_read_b64_tr_b16 v[14:15], v115 offset:41504
    ds_read_b64_tr_b16 v[28:29], v117 offset:45312
    ds_read_b64_tr_b16 v[30:31], v117 offset:45600
    ds_read_b64_tr_b16 v[44:45], v117 offset:45344
    ds_read_b64_tr_b16 v[46:47], v117 offset:45632
    s_waitcnt lgkmcnt(15)
    v_mfma_f32_16x16x32_bf16 v[64:67], v[0:3], v[16:19], 0
    v_mfma_f32_16x16x32_bf16 v[68:71], v[0:3], v[32:35], 0
    s_waitcnt lgkmcnt(12)
    v_mfma_f32_16x16x32_bf16 v[64:67], v[4:7], v[20:23], v[64:67]
    v_mfma_f32_16x16x32_bf16 v[68:71], v[4:7], v[36:39], v[68:71]
    s_waitcnt lgkmcnt(6)
    v_mfma_f32_16x16x32_bf16 v[64:67], v[8:11], v[24:27], v[64:67]
    v_mfma_f32_16x16x32_bf16 v[68:71], v[8:11], v[40:43], v[68:71]
    s_waitcnt lgkmcnt(0)
    v_mfma_f32_16x16x32_bf16 v[64:67], v[12:15], v[28:31], v[64:67]
    v_mfma_f32_16x16x32_bf16 v[68:71], v[12:15], v[44:47], v[68:71]
    v_mov_b32 v90, 0
    s_nop 5
    v_cvt_pk_bf16_f32 v72, v64, v65
    v_cvt_pk_bf16_f32 v73, v66, v67
    v_cvt_pk_bf16_f32 v74, v68, v69
    v_cvt_pk_bf16_f32 v75, v70, v71
    s_nop 0
    v_permlane16_swap_b32 v72, v74
    v_permlane16_swap_b32 v73, v75
    buffer_store_dwordx4 v[72:75], v250, s[12:15], s89 offen sc1
    ds_read_b128 v[32:35], v250 offset:16384
    ds_read_b128 v[36:39], v250 offset:57344
    ds_read_b128 v[40:43], v254 offset:16384
    ds_read_b32 v16, v100 offset:0
    ds_read_b32 v17, v101 offset:0
    ds_read_b32 v18, v100 offset:1024
    ds_read_b32 v19, v101 offset:1024
    ds_read_b32 v20, v100 offset:2048
    ds_read_b32 v21, v101 offset:2048
    ds_read_b32 v22, v100 offset:3072
    ds_read_b32 v23, v101 offset:3072
    ds_read_b32 v24, v100 offset:4096
    ds_read_b32 v25, v101 offset:4096
    ds_read_b32 v26, v100 offset:5120
    ds_read_b32 v27, v101 offset:5120
    ds_read_b32 v28, v100 offset:6144
    ds_read_b32 v29, v101 offset:6144
    ds_read_b128 v[44:47], v254 offset:57344
    ds_read_b128 v[48:51], v250 offset:17408
    s_waitcnt lgkmcnt(15)
    v_mfma_f32_32x32x16_bf16 v[0:15], v[32:35], v[128:131], 0
    ds_read_b128 v[52:55], v250 offset:58368
    buffer_load_dwordx4 v87, s[40:43], s21 offen offset:3072 lds
    s_mul_i32 s21, s22, -2
    s_add_u32 s21, s21, s81
    s_add_u32 s21, s21, 4
    s_and_b32 s21, s21, s23
    s_lshr_b32 s63, s21, 1
    s_mul_i32 s63, s63, s24
    s_add_u32 s21, s21, s63
    s_mul_i32 s21, s21, s20
    s_add_u32 s21, s21, s86
    s_add_u32 m0, s69, 24576
    s_nop 0
    buffer_load_dwordx4 v84, s[40:43], s21 offen offset:0 lds
    buffer_load_dwordx4 v85, s[40:43], s21 offen offset:1024 lds
    v_mfma_f32_32x32x16_bf16 v[0:15], v[36:39], v[132:135], v[0:15]
    ds_read_b128 v[56:59], v254 offset:17408
    buffer_load_dwordx4 v86, s[40:43], s21 offen offset:2048 lds
    buffer_load_dwordx4 v87, s[40:43], s21 offen offset:3072 lds
    ds_read_b64_tr_b16 a[0:1], v88 offset:32768
    v_mfma_f32_32x32x16_bf16 v[0:15], v[40:43], v[136:139], v[0:15]
    ds_read_b128 v[60:63], v254 offset:58368
    s_waitcnt lgkmcnt(6)
    v_add_f32 v90, v90, v16
    ds_read_b64_tr_b16 a[2:3], v88 offset:33280
    ds_read_b64_tr_b16 a[4:5], v89 offset:32768
    ds_read_b64_tr_b16 a[6:7], v89 offset:33280
    s_waitcnt lgkmcnt(8)
    v_mfma_f32_32x32x16_bf16 v[0:15], v[44:47], v[140:143], v[0:15]
    ds_read_b128 v[32:35], v250 offset:18432
    v_add_f32 v90, v90, v17
    ds_read_b64_tr_b16 a[8:9], v88 offset:34816
    ds_read_b64_tr_b16 a[10:11], v88 offset:35328
    ds_read_b64_tr_b16 a[12:13], v89 offset:34816
    s_waitcnt lgkmcnt(11)
    v_mfma_f32_32x32x16_bf16 v[0:15], v[48:51], v[144:147], v[0:15]
    ds_read_b128 v[36:39], v250 offset:59392
    v_add_f32 v90, v90, v18
    ds_read_b64_tr_b16 a[14:15], v89 offset:35328
    s_cbranch_vccz NW_1
    s_waitcnt vmcnt(13)
NW_1:
    ds_read_b64_tr_b16 a[128:129], v88 offset:36864
    ds_read_b64_tr_b16 a[130:131], v88 offset:37376
    s_waitcnt lgkmcnt(14)
    v_mfma_f32_32x32x16_bf16 v[0:15], v[52:55], v[148:151], v[0:15]
    ds_read_b128 v[40:43], v254 offset:18432
    v_add_f32 v90, v90, v19
    ds_read_b64_tr_b16 a[132:133], v89 offset:36864
    ds_read_b64_tr_b16 a[134:135], v89 offset:37376
    ds_read_b64_tr_b16 a[136:137], v88 offset:38912
    s_waitcnt lgkmcnt(15)
    v_mfma_f32_32x32x16_bf16 v[0:15], v[56:59], v[152:155], v[0:15]
    ds_read_b128 v[44:47], v254 offset:59392
    v_add_f32 v90, v90, v20
    ds_read_b64_tr_b16 a[138:139], v88 offset:39424
    ds_read_b64_tr_b16 a[140:141], v89 offset:38912
    ds_read_b64_tr_b16 a[142:143], v89 offset:39424
    v_mfma_f32_32x32x16_bf16 v[0:15], v[60:63], v[156:159], v[0:15]
    ds_read_b128 v[48:51], v250 offset:19456
    v_add_f32 v90, v90, v21
    s_add_u32 s21, s81, 2
    s_and_b32 s21, s21, s23
    s_lshr_b32 s63, s21, 1
    s_mul_i32 s63, s63, s24
    s_add_u32 s21, s21, s63
    s_lshl_b32 s63, s22, 5
    s_add_u32 s21, s21, s63
    s_mov_b32 s42, s46
    s_mul_i32 s21, s21, s20
    s_add_u32 s21, s21, s86
    s_add_u32 m0, s69, 28672
    s_nop 0
    buffer_load_dwordx4 v84, s[40:43], s21 offen offset:0 lds
    buffer_load_dwordx4 v85, s[40:43], s21 offen offset:1024 lds
    buffer_load_dwordx4 v86, s[40:43], s21 offen offset:2048 lds
    s_waitcnt lgkmcnt(15)
    v_mfma_f32_32x32x16_bf16 v[0:15], v[32:35], v[160:163], v[0:15]
    ds_read_b128 v[52:55], v250 offset:60416
    v_add_f32 v90, v90, v22
    buffer_load_dwordx4 v87, s[40:43], s21 offen offset:3072 lds
    s_cbranch_vccz NW_2
    s_waitcnt vmcnt(13)
NW_2:
    ds_read_b64_tr_b16 a[16:17], v88 offset:12288
    ds_read_b64_tr_b16 a[18:19], v88 offset:12800
    s_waitcnt lgkmcnt(15)
    v_mfma_f32_32x32x16_bf16 v[0:15], v[36:39], v[164:167], v[0:15]
    ds_read_b128 v[56:59], v254 offset:19456
    v_add_f32 v90, v90, v23
    ds_read_b64_tr_b16 a[20:21], v89 offset:12288
    ds_read_b64_tr_b16 a[22:23], v89 offset:12800
    ds_read_b64_tr_b16 a[24:25], v88 offset:14336
    s_waitcnt lgkmcnt(15)
    v_mfma_f32_32x32x16_bf16 v[0:15], v[40:43], v[168:171], v[0:15]
    ds_read_b128 v[60:63], v254 offset:60416
    v_add_f32 v90, v90, v24
    ds_read_b64_tr_b16 a[26:27], v88 offset:14848
    ds_read_b64_tr_b16 a[28:29], v89 offset:14336
    ds_read_b64_tr_b16 a[30:31], v89 offset:14848
    s_waitcnt lgkmcnt(15)
    v_mfma_f32_32x32x16_bf16 v[0:15], v[44:47], v[172:175], v[0:15]
    ds_read_b128 v[32:35], v250 offset:20480
    v_add_f32 v90, v90, v25
    s_add_u32 s21, s81, 3
    s_and_b32 s21, s21, s23
    s_lshr_b32 s63, s21, 1
    s_mul_i32 s63, s63, s24
    s_add_u32 s21, s21, s63
    s_mul_i32 s21, s21, s20
    s_add_u32 s21, s21, s86
    s_add_u32 m0, s69, 32768
    s_nop 0
    buffer_load_dwordx4 v84, s[40:43], s21 offen offset:0 lds
    buffer_load_dwordx4 v85, s[40:43], s21 offen offset:1024 lds
    buffer_load_dwordx4 v86, s[40:43], s21 offen offset:2048 lds
    s_waitcnt lgkmcnt(12)
    v_mfma_f32_32x32x16_bf16 v[0:15], v[48:51], v[176:179], v[0:15]
    ds_read_b128 v[36:39], v250 offset:61440
    v_add_f32 v90, v90, v26
    buffer_load_dwordx4 v87, s[40:43], s21 offen offset:3072 lds
    s_cbranch_vccz NW_3
    s_waitcnt vmcnt(12)
NW_3:
    ds_read_b64_tr_b16 a[144:145], v88 offset:8192
    ds_read_b64_tr_b16 a[146:147], v88 offset:8704
    s_waitcnt lgkmcnt(14)
    v_mfma_f32_32x32x16_bf16 v[0:15], v[52:55], v[180:183], v[0:15]
    ds_read_b128 v[40:43], v254 offset:20480
    v_add_f32 v90, v90, v27
    ds_read_b64_tr_b16 a[148:149], v89 offset:8192
    ds_read_b64_tr_b16 a[150:151], v89 offset:8704
    ds_read_b64_tr_b16 a[152:153], v88 offset:10240
    s_waitcnt lgkmcnt(15)
    v_mfma_f32_32x32x16_bf16 v[0:15], v[56:59], v[184:187], v[0:15]
    ds_read_b128 v[44:47], v254 offset:61440
    v_add_f32 v90, v90, v28
    ds_read_b64_tr_b16 a[154:155], v88 offset:10752
    ds_read_b64_tr_b16 a[156:157], v89 offset:10240
    ds_read_b64_tr_b16 a[158:159], v89 offset:10752
    s_waitcnt lgkmcnt(15)
    v_mfma_f32_32x32x16_bf16 v[0:15], v[60:63], v[188:191], v[0:15]
    ds_read_b128 v[48:51], v250 offset:21504
    v_add_f32 v90, v90, v29
    s_add_u32 s21, s81, 3
    s_and_b32 s21, s21, s23
    s_lshr_b32 s63, s21, 1
    s_mul_i32 s63, s63, s24
    s_add_u32 s21, s21, s63
    s_lshl_b32 s63, s22, 5
    s_add_u32 s21, s21, s63
    s_mul_i32 s21, s21, s20
    s_add_u32 s21, s21, s86
    s_add_u32 m0, s69, 36864
    s_nop 0
    buffer_load_dwordx4 v84, s[40:43], s21 offen offset:0 lds
    buffer_load_dwordx4 v85, s[40:43], s21 offen offset:1024 lds
    buffer_load_dwordx4 v86, s[40:43], s21 offen offset:2048 lds
    s_waitcnt lgkmcnt(12)
    v_mfma_f32_32x32x16_bf16 v[0:15], v[32:35], v[192:195], v[0:15]
    ds_read_b128 v[52:55], v250 offset:62464
    s_mov_b32 s8, 131072
    buffer_load_dwordx4 v[108:111], v250, s[12:15], s8 offen sc1
    buffer_load_dwordx4 v87, s[40:43], s21 offen offset:3072 lds
    s_cbranch_vccz NW_4
    s_waitcnt vmcnt(13)
NW_4:
    ds_read_b64_tr_b16 a[32:33], v88 offset:24576
    ds_read_b64_tr_b16 a[34:35], v88 offset:25088
    s_waitcnt lgkmcnt(14)
    v_mfma_f32_32x32x16_bf16 v[0:15], v[36:39], v[196:199], v[0:15]
    ds_read_b128 v[56:59], v254 offset:21504
    ds_read_b64_tr_b16 a[36:37], v89 offset:24576
    ds_read_b64_tr_b16 a[38:39], v89 offset:25088
    ds_read_b64_tr_b16 a[40:41], v88 offset:26624
    s_waitcnt lgkmcnt(15)
    v_mfma_f32_32x32x16_bf16 v[0:15], v[40:43], v[200:203], v[0:15]
    ds_read_b128 v[60:63], v254 offset:62464
    ds_read_b64_tr_b16 a[42:43], v88 offset:27136
    ds_read_b64_tr_b16 a[44:45], v89 offset:26624
    ds_read_b64_tr_b16 a[46:47], v89 offset:27136
    s_waitcnt lgkmcnt(15)
    v_mfma_f32_32x32x16_bf16 v[0:15], v[44:47], v[204:207], v[0:15]
    ds_read_b128 v[32:35], v250 offset:22528
    s_add_u32 s21, s81, 4
    s_and_b32 s21, s21, s23
    s_lshr_b32 s63, s21, 1
    s_mul_i32 s63, s63, s24
    s_add_u32 s21, s21, s63
    s_mul_i32 s21, s21, s20
    s_add_u32 s21, s21, s86
    s_add_u32 m0, s69, 12288
    s_nop 0
    buffer_load_dwordx4 v84, s[40:43], s21 offen offset:0 lds
    buffer_load_dwordx4 v85, s[40:43], s21 offen offset:1024 lds
    buffer_load_dwordx4 v86, s[40:43], s21 offen offset:2048 lds
    s_waitcnt lgkmcnt(12)
    v_mfma_f32_32x32x16_bf16 v[0:15], v[48:51], v[208:211], v[0:15]
    ds_read_b128 v[36:39], v250 offset:63488
    buffer_load_dwordx4 v87, s[40:43], s21 offen offset:3072 lds
    s_cbranch_vccz NW_5
    s_waitcnt vmcnt(13)
NW_5:
    ds_read_b64_tr_b16 a[160:161], v88 offset:28672
    ds_read_b64_tr_b16 a[162:163], v88 offset:29184
    s_waitcnt lgkmcnt(14)
    v_mfma_f32_32x32x16_bf16 v[0:15], v[52:55], v[212:215], v[0:15]
    ds_read_b128 v[40:43], v254 offset:22528
    ds_read_b64_tr_b16 a[164:165], v89 offset:28672
    ds_read_b64_tr_b16 a[166:167], v89 offset:29184
    ds_read_b64_tr_b16 a[168:169], v88 offset:30720
    s_waitcnt lgkmcnt(15)
    v_mfma_f32_32x32x16_bf16 v[0:15], v[56:59], v[216:219], v[0:15]
    ds_read_b128 v[44:47], v254 offset:63488
    ds_read_b64_tr_b16 a[170:171], v88 offset:31232
    ds_read_b64_tr_b16 a[172:173], v89 offset:30720
    ds_read_b64_tr_b16 a[174:175], v89 offset:31232
    s_waitcnt lgkmcnt(15)
    v_mfma_f32_32x32x16_bf16 v[0:15], v[60:63], v[220:223], v[0:15]
    s_add_u32 s21, s81, 4
    s_and_b32 s21, s21, s23
    s_lshr_b32 s63, s21, 1
    s_mul_i32 s63, s63, s24
    s_add_u32 s21, s21, s63
    s_lshl_b32 s63, s22, 5
    s_add_u32 s21, s21, s63
    s_mul_i32 s21, s21, s20
    s_add_u32 s21, s21, s86
    s_add_u32 m0, s69, 8192
    s_nop 0
    buffer_load_dwordx4 v84, s[40:43], s21 offen offset:0 lds
    buffer_load_dwordx4 v85, s[40:43], s21 offen offset:1024 lds
    buffer_load_dwordx4 v86, s[40:43], s21 offen offset:2048 lds
    s_waitcnt lgkmcnt(11)
    v_mfma_f32_32x32x16_bf16 v[0:15], v[32:35], v[224:227], v[0:15]
    buffer_load_dwordx4 v87, s[40:43], s21 offen offset:3072 lds
    s_add_u32 s85, s33, 0
    buffer_load_dwordx4 v[128:131], v250, s[12:15], s85 offen offset:0 sc1
    s_waitcnt lgkmcnt(10)
    v_mfma_f32_32x32x16_bf16 v[0:15], v[36:39], v[228:231], v[0:15]
    s_add_u32 s85, s33, 0
    buffer_load_dwordx4 v[132:135], v250, s[12:15], s85 offen offset:1024 sc1
    s_waitcnt lgkmcnt(7)
    v_mfma_f32_32x32x16_bf16 v[0:15], v[40:43], v[232:235], v[0:15]
    s_add_u32 s85, s33, 0
    buffer_load_dwordx4 v[136:139], v250, s[12:15], s85 offen offset:2048 sc1
    s_waitcnt lgkmcnt(3)
    v_mfma_f32_32x32x16_bf16 v[0:15], v[44:47], v[236:239], v[0:15]
    s_add_u32 s85, s33, 0
    buffer_load_dwordx4 v[140:143], v250, s[12:15], s85 offen offset:3072 sc1
    v_mov_b32 v242, v90
    s_nop 1
    v_permlane32_swap_b32 v242, v90
    v_add_f32 v90, v90, v242
    v_cvt_pk_bf16_f32 v73, v90, 0
    v_lshlrev_b32 v242, 16, v73
    v_sub_f32 v242, v90, v242
    v_cvt_pk_bf16_f32 v72, v90, v242
    v_mov_b32 v74, 0
    v_mov_b32 v75, 0
    s_nop 1
    v_mfma_f32_32x32x16_bf16 v[0:15], v[72:75], v[80:83], v[0:15]
    s_nop 11
    v_pk_mul_f32 v[0:1], v[0:1], v[102:103] op_sel_hi:[1,0]
    v_pk_mul_f32 v[2:3], v[2:3], v[102:103] op_sel_hi:[1,0]
    v_pk_mul_f32 v[4:5], v[4:5], v[102:103] op_sel_hi:[1,0]
    v_pk_mul_f32 v[6:7], v[6:7], v[102:103] op_sel_hi:[1,0]
    v_pk_mul_f32 v[8:9], v[8:9], v[102:103] op_sel_hi:[1,0]
    v_pk_mul_f32 v[10:11], v[10:11], v[102:103] op_sel_hi:[1,0]
    v_pk_mul_f32 v[12:13], v[12:13], v[102:103] op_sel_hi:[1,0]
    v_pk_mul_f32 v[14:15], v[14:15], v[102:103] op_sel_hi:[1,0]
    v_cvt_pk_bf16_f32 v64, v0, v1
    v_cvt_pk_bf16_f32 v65, v2, v3
    v_cvt_pk_bf16_f32 v66, v4, v5
    v_cvt_pk_bf16_f32 v67, v6, v7
    v_cvt_pk_bf16_f32 v68, v8, v9
    v_cvt_pk_bf16_f32 v69, v10, v11
    v_cvt_pk_bf16_f32 v70, v12, v13
    v_cvt_pk_bf16_f32 v71, v14, v15
    v_cndmask_b32 v70, v70, 0, s[60:61]
    v_cndmask_b32 v71, v71, 0, s[60:61]
    v_mfma_f32_32x32x16_bf16 v[0:15], v[92:95], v[64:67], 0
    s_nop 0
    v_mfma_f32_32x32x16_bf16 v[0:15], v[96:99], v[68:71], v[0:15]
    s_barrier
    s_nop 10
    v_max3_f32 v126, v0, v1, v2
    v_min3_f32 v90, v0, v1, v2
    v_max3_f32 v127, v3, v4, v5
    v_min3_f32 v91, v3, v4, v5
    v_max3_f32 v126, v126, v6, v7
    v_min3_f32 v90, v90, v6, v7
    v_max3_f32 v127, v127, v8, v9
    v_min3_f32 v91, v91, v8, v9
    v_max3_f32 v126, v126, v10, v11
    v_min3_f32 v90, v90, v10, v11
    v_max3_f32 v127, v127, v12, v13
    v_min3_f32 v91, v91, v12, v13
    v_max3_f32 v126, v126, v14, v15
    v_min3_f32 v90, v90, v14, v15
    v_max_f32 v126, v126, v127
    v_min_f32 v90, v90, v91
    v_mov_b32 v127, v126
    v_mov_b32 v91, v90
    s_nop 0
    v_permlane32_swap_b32 v126, v127
    v_permlane32_swap_b32 v90, v91
    v_max_f32 v126, v126, v127
    v_min_f32 v90, v90, v91
    v_pk_add_f32 v[16:17], v[0:1], v[126:127] op_sel_hi:[1,0] neg_lo:[0,1] neg_hi:[0,1]
    v_pk_add_f32 v[18:19], v[2:3], v[126:127] op_sel_hi:[1,0] neg_lo:[0,1] neg_hi:[0,1]
    v_pk_add_f32 v[20:21], v[4:5], v[126:127] op_sel_hi:[1,0] neg_lo:[0,1] neg_hi:[0,1]
    v_pk_add_f32 v[22:23], v[6:7], v[126:127] op_sel_hi:[1,0] neg_lo:[0,1] neg_hi:[0,1]
    v_pk_add_f32 v[24:25], v[8:9], v[126:127] op_sel_hi:[1,0] neg_lo:[0,1] neg_hi:[0,1]
    v_pk_add_f32 v[26:27], v[10:11], v[126:127] op_sel_hi:[1,0] neg_lo:[0,1] neg_hi:[0,1]
    v_pk_add_f32 v[28:29], v[12:13], v[126:127] op_sel_hi:[1,0] neg_lo:[0,1] neg_hi:[0,1]
    v_pk_add_f32 v[30:31], v[14:15], v[126:127] op_sel_hi:[1,0] neg_lo:[0,1] neg_hi:[0,1]
    v_pk_add_f32 v[0:1], v[0:1], v[90:91] op_sel_hi:[1,0] neg_lo:[1,0] neg_hi:[1,0]
    v_pk_add_f32 v[2:3], v[2:3], v[90:91] op_sel_hi:[1,0] neg_lo:[1,0] neg_hi:[1,0]
    v_pk_add_f32 v[4:5], v[4:5], v[90:91] op_sel_hi:[1,0] neg_lo:[1,0] neg_hi:[1,0]
    v_pk_add_f32 v[6:7], v[6:7], v[90:91] op_sel_hi:[1,0] neg_lo:[1,0] neg_hi:[1,0]
    v_pk_add_f32 v[8:9], v[8:9], v[90:91] op_sel_hi:[1,0] neg_lo:[1,0] neg_hi:[1,0]
    v_pk_add_f32 v[10:11], v[10:11], v[90:91] op_sel_hi:[1,0] neg_lo:[1,0] neg_hi:[1,0]
    v_pk_add_f32 v[12:13], v[12:13], v[90:91] op_sel_hi:[1,0] neg_lo:[1,0] neg_hi:[1,0]
    v_pk_add_f32 v[14:15], v[14:15], v[90:91] op_sel_hi:[1,0] neg_lo:[1,0] neg_hi:[1,0]
    v_exp_f32 v16, v16
    v_exp_f32 v17, v17
    v_exp_f32 v18, v18
    v_exp_f32 v19, v19
    v_exp_f32 v20, v20
    v_exp_f32 v21, v21
    v_exp_f32 v22, v22
    v_exp_f32 v23, v23
    s_mov_b32 s84, 40000
    s_waitcnt vmcnt(13)
    v_xor_b32 v108, s67, v108
    v_bitop3_b32 v108, s67, v109, v108 bitop3:0xbe
    v_bitop3_b32 v108, s67, v110, v108 bitop3:0xbe
    v_bitop3_b32 v108, s67, v111, v108 bitop3:0xbe
    v_cmp_ne_u32 vcc, 0, v108
    s_cbranch_vccnz FCS
FCR:
    s_cmp_lt_u32 s71, 28
    s_cselect_b64 vcc, -1, 0
    s_add_u32 s25, s32, 0
    s_add_u32 s26, s32, 4096
    s_add_u32 s27, s32, 8192
    s_add_u32 s28, s32, 12288
    buffer_load_dwordx4 v[192:195], v250, s[12:15], s25 offen offset:0 sc1
    buffer_load_dwordx4 v[196:199], v250, s[12:15], s25 offen offset:1024 sc1
    buffer_load_dwordx4 v[200:203], v250, s[12:15], s25 offen offset:2048 sc1
    buffer_load_dwordx4 v[204:207], v250, s[12:15], s25 offen offset:3072 sc1
    v_exp_f32 v24, v24
    v_exp_f32 v25, v25
    v_exp_f32 v26, v26
    v_exp_f32 v27, v27
    v_exp_f32 v28, v28
    v_exp_f32 v29, v29
    v_exp_f32 v30, v30
    v_exp_f32 v31, v31
    buffer_load_dwordx4 v[208:211], v250, s[12:15], s26 offen offset:0 sc1
    buffer_load_dwordx4 v[212:215], v250, s[12:15], s26 offen offset:1024 sc1
    buffer_load_dwordx4 v[216:219], v250, s[12:15], s26 offen offset:2048 sc1
    buffer_load_dwordx4 v[220:223], v250, s[12:15], s26 offen offset:3072 sc1
    v_exp_f32 v0, v0
    v_exp_f32 v1, v1
    v_exp_f32 v2, v2
    v_exp_f32 v3, v3
    v_exp_f32 v4, v4
    v_exp_f32 v5, v5
    v_exp_f32 v6, v6
    v_exp_f32 v7, v7
    v_exp_f32 v8, v8
    v_exp_f32 v9, v9
    v_exp_f32 v10, v10
    v_exp_f32 v11, v11
    v_exp_f32 v12, v12
    v_exp_f32 v13, v13
    v_exp_f32 v14, v14
    v_exp_f32 v15, v15
    v_pk_add_f32 v[72:73], v[16:17], v[18:19]
    v_pk_add_f32 v[74:75], v[28:29], v[30:31]
    v_pk_add_f32 v[76:77], v[0:1], v[2:3]
    v_pk_add_f32 v[78:79], v[12:13], v[14:15]
    v_pk_add_f32 v[72:73], v[72:73], v[20:21]
    v_pk_add_f32 v[76:77], v[76:77], v[4:5]
    v_pk_add_f32 v[72:73], v[72:73], v[22:23]
    v_pk_add_f32 v[76:77], v[76:77], v[6:7]
    v_pk_add_f32 v[72:73], v[72:73], v[24:25]
    v_pk_add_f32 v[76:77], v[76:77], v[8:9]
    v_pk_add_f32 v[72:73], v[72:73], v[26:27]
    v_pk_add_f32 v[76:77], v[76:77], v[10:11]
    v_pk_fma_f32 v[72:73], v[74:75], v[106:107], v[72:73] op_sel_hi:[1,0,1]
    v_pk_fma_f32 v[76:77], v[78:79], v[106:107], v[76:77] op_sel_hi:[1,0,1]
    v_add_f32 v72, v72, v73
    v_add_f32 v76, v76, v77
    v_mov_b32 v73, v72
    v_mov_b32 v77, v76
    s_nop 0
    v_permlane32_swap_b32 v72, v73
    v_permlane32_swap_b32 v76, v77
    v_add_f32 v72, v72, v73
    v_add_f32 v76, v76, v77
    v_rcp_f32 v72, v72
    v_rcp_f32 v76, v76
    v_pk_mul_f32 v[16:17], v[16:17], v[72:73] op_sel_hi:[1,0]
    v_pk_mul_f32 v[18:19], v[18:19], v[72:73] op_sel_hi:[1,0]
    v_pk_mul_f32 v[20:21], v[20:21], v[72:73] op_sel_hi:[1,0]
    v_pk_mul_f32 v[22:23], v[22:23], v[72:73] op_sel_hi:[1,0]
    v_pk_mul_f32 v[24:25], v[24:25], v[72:73] op_sel_hi:[1,0]
    v_pk_mul_f32 v[26:27], v[26:27], v[72:73] op_sel_hi:[1,0]
    v_pk_mul_f32 v[28:29], v[28:29], v[72:73] op_sel_hi:[1,0]
    v_pk_mul_f32 v[30:31], v[30:31], v[72:73] op_sel_hi:[1,0]
    v_cvt_pk_bf16_f32 v48, v16, v17
    v_cvt_pk_bf16_f32 v49, v18, v19
    v_cvt_pk_bf16_f32 v50, v20, v21
    v_cvt_pk_bf16_f32 v51, v22, v23
    v_cvt_pk_bf16_f32 v52, v24, v25
    v_cvt_pk_bf16_f32 v53, v26, v27
    v_cvt_pk_bf16_f32 v54, v28, v29
    v_cvt_pk_bf16_f32 v55, v30, v31
    buffer_load_dwordx4 v[224:227], v250, s[12:15], s27 offen offset:0 sc1
    buffer_load_dwordx4 v[228:231], v250, s[12:15], s27 offen offset:1024 sc1
    buffer_load_dwordx4 v[232:235], v250, s[12:15], s27 offen offset:2048 sc1
    buffer_load_dwordx4 v[236:239], v250, s[12:15], s27 offen offset:3072 sc1
    v_pk_mul_f32 v[0:1], v[0:1], v[76:77] op_sel_hi:[1,0]
    v_pk_mul_f32 v[2:3], v[2:3], v[76:77] op_sel_hi:[1,0]
    v_pk_mul_f32 v[4:5], v[4:5], v[76:77] op_sel_hi:[1,0]
    v_pk_mul_f32 v[6:7], v[6:7], v[76:77] op_sel_hi:[1,0]
    v_pk_mul_f32 v[8:9], v[8:9], v[76:77] op_sel_hi:[1,0]
    v_pk_mul_f32 v[10:11], v[10:11], v[76:77] op_sel_hi:[1,0]
    v_pk_mul_f32 v[12:13], v[12:13], v[76:77] op_sel_hi:[1,0]
    v_pk_mul_f32 v[14:15], v[14:15], v[76:77] op_sel_hi:[1,0]
    v_cvt_pk_bf16_f32 v56, v0, v1
    v_cvt_pk_bf16_f32 v57, v2, v3
    v_cvt_pk_bf16_f32 v58, v4, v5
    v_cvt_pk_bf16_f32 v59, v6, v7
    v_cvt_pk_bf16_f32 v60, v8, v9
    v_cvt_pk_bf16_f32 v61, v10, v11
    v_cvt_pk_bf16_f32 v62, v12, v13
    v_cvt_pk_bf16_f32 v63, v14, v15
    buffer_load_dwordx4 v[32:35], v250, s[12:15], s28 offen offset:0 sc1
    buffer_load_dwordx4 v[36:39], v250, s[12:15], s28 offen offset:1024 sc1
    buffer_load_dwordx4 v[40:43], v250, s[12:15], s28 offen offset:2048 sc1
    buffer_load_dwordx4 v[44:47], v250, s[12:15], s28 offen offset:3072 sc1
    s_mov_b32 s84, 40000
KVR:
    s_waitcnt vmcnt(15)
    v_mfma_f32_32x32x16_bf16 v[0:15], v[120:123], v[192:195], 0
    s_waitcnt vmcnt(14)
    v_mfma_f32_32x32x16_bf16 v[0:15], v[120:123], v[196:199], v[0:15]
    s_waitcnt vmcnt(13)
    v_mfma_f32_32x32x16_bf16 v[0:15], v[120:123], v[200:203], v[0:15]
    v_max3_u32 v90, v192, v196, v200
    s_waitcnt vmcnt(12)
    v_mfma_f32_32x32x16_bf16 v[0:15], v[120:123], v[204:207], v[0:15]
    s_waitcnt vmcnt(11)
    v_mfma_f32_32x32x16_bf16 v[0:15], v[120:123], v[208:211], v[0:15]
    v_max3_u32 v90, v90, v204, v208
    s_add_u32 s85, s33, 4096
    buffer_load_dwordx4 v[144:147], v250, s[12:15], s85 offen offset:0 sc1
    s_waitcnt vmcnt(11)
    v_mfma_f32_32x32x16_bf16 v[0:15], v[120:123], v[212:215], v[0:15]
    s_add_u32 s85, s33, 4096
    buffer_load_dwordx4 v[148:151], v250, s[12:15], s85 offen offset:1024 sc1
    s_waitcnt vmcnt(11)
    v_mfma_f32_32x32x16_bf16 v[0:15], v[120:123], v[216:219], v[0:15]
    v_max3_u32 v90, v90, v212, v216
    s_add_u32 s85, s33, 4096
    buffer_load_dwordx4 v[152:155], v250, s[12:15], s85 offen offset:2048 sc1
    s_waitcnt vmcnt(11)
    v_mfma_f32_32x32x16_bf16 v[0:15], v[120:123], v[220:223], v[0:15]
    s_add_u32 s85, s33, 4096
    buffer_load_dwordx4 v[156:159], v250, s[12:15], s85 offen offset:3072 sc1
    s_waitcnt vmcnt(11)
    v_mfma_f32_32x32x16_bf16 v[0:15], v[120:123], v[224:227], v[0:15]
    v_max3_u32 v90, v90, v220, v224
    s_add_u32 s85, s33, 8192
    buffer_load_dwordx4 v[160:163], v250, s[12:15], s85 offen offset:0 sc1
    s_waitcnt vmcnt(11)
    v_mfma_f32_32x32x16_bf16 v[0:15], v[120:123], v[228:231], v[0:15]
    s_add_u32 s85, s33, 8192
    buffer_load_dwordx4 v[164:167], v250, s[12:15], s85 offen offset:1024 sc1
    s_waitcnt vmcnt(11)
    v_mfma_f32_32x32x16_bf16 v[0:15], v[120:123], v[232:235], v[0:15]
    v_max3_u32 v90, v90, v228, v232
    s_waitcnt vmcnt(10)
    v_mfma_f32_32x32x16_bf16 v[0:15], v[120:123], v[236:239], v[0:15]
    s_waitcnt vmcnt(9)
    v_mfma_f32_32x32x16_bf16 v[0:15], v[120:123], v[32:35], v[0:15]
    v_max3_u32 v90, v90, v236, v32
    s_waitcnt vmcnt(8)
    v_mfma_f32_32x32x16_bf16 v[0:15], v[120:123], v[36:39], v[0:15]
    s_waitcnt vmcnt(7)
    v_mfma_f32_32x32x16_bf16 v[0:15], v[120:123], v[40:43], v[0:15]
    v_max3_u32 v90, v90, v36, v40
    s_waitcnt vmcnt(6)
    v_mfma_f32_32x32x16_bf16 v[0:15], v[120:123], v[44:47], v[0:15]
    v_max3_u32 v90, v90, v44, v44
    v_cmp_eq_u32 vcc, -1, v90
    s_cbranch_vccnz KVS_
    s_nop 8
    v_cvt_pk_bf16_f32 v64, v0, v1
    v_cvt_pk_bf16_f32 v65, v2, v3
    v_cvt_pk_bf16_f32 v66, v4, v5
    v_cvt_pk_bf16_f32 v67, v6, v7
    ds_write_b128 v253, v[64:67] offset:16384
    s_add_u32 s85, s33, 8192
    buffer_load_dwordx4 v[168:171], v250, s[12:15], s85 offen offset:2048 sc1
    s_add_u32 s85, s33, 8192
    buffer_load_dwordx4 v[172:175], v250, s[12:15], s85 offen offset:3072 sc1
    s_waitcnt lgkmcnt(0)
    s_barrier
    ds_read_b128 v[16:19], v250 offset:16384
    ds_read_b128 v[20:23], v250 offset:57344
    ds_read_b128 v[24:27], v254 offset:16384
    ds_read_b128 v[28:31], v254 offset:57344
    s_add_u32 s85, s33, 12288
    buffer_load_dwordx4 v[176:179], v250, s[12:15], s85 offen offset:0 sc1
    s_add_u32 s85, s33, 12288
    buffer_load_dwordx4 v[180:183], v250, s[12:15], s85 offen offset:1024 sc1
    s_waitcnt lgkmcnt(3)
    v_mfma_f32_32x32x16_bf16 v[0:15], v[16:19], v[48:51], 0
    s_add_u32 s85, s33, 12288
    buffer_load_dwordx4 v[184:187], v250, s[12:15], s85 offen offset:2048 sc1
    s_waitcnt lgkmcnt(2)
    v_mfma_f32_32x32x16_bf16 v[0:15], v[20:23], v[52:55], v[0:15]
    s_add_u32 s85, s33, 12288
    buffer_load_dwordx4 v[188:191], v250, s[12:15], s85 offen offset:3072 sc1
    s_waitcnt lgkmcnt(1)
    v_mfma_f32_32x32x16_bf16 v[0:15], v[24:27], v[56:59], v[0:15]
    s_add_u32 s85, s33, 16384
    buffer_load_dwordx4 v[192:195], v250, s[12:15], s85 offen offset:0 sc1
    s_waitcnt lgkmcnt(0)
    v_mfma_f32_32x32x16_bf16 v[0:15], v[28:31], v[60:63], v[0:15]
    s_add_u32 s85, s33, 16384
    buffer_load_dwordx4 v[196:199], v250, s[12:15], s85 offen offset:1024 sc1
    s_nop 9
    v_mov_b32 v102, v12
    v_mov_b32 v103, v12
    s_nop 1
    v_permlane32_swap_b32 v103, v102
    v_add_f32 v102, 0x358637bd, v102
    v_rcp_f32 v102, v102
    s_nop 0
    v_pk_mul_f32 v[0:1], v[0:1], v[102:103] op_sel_hi:[1,0]
    v_pk_mul_f32 v[2:3], v[2:3], v[102:103] op_sel_hi:[1,0]
    v_pk_mul_f32 v[4:5], v[4:5], v[102:103] op_sel_hi:[1,0]
    v_pk_mul_f32 v[6:7], v[6:7], v[102:103] op_sel_hi:[1,0]
    v_pk_mul_f32 v[8:9], v[8:9], v[102:103] op_sel_hi:[1,0]
    v_pk_mul_f32 v[10:11], v[10:11], v[102:103] op_sel_hi:[1,0]
    v_pk_mul_f32 v[12:13], v[12:13], v[102:103] op_sel_hi:[1,0]
    v_pk_mul_f32 v[14:15], v[14:15], v[102:103] op_sel_hi:[1,0]
    v_cvt_pk_bf16_f32 v64, v0, v1
    v_cvt_pk_bf16_f32 v65, v2, v3
    v_cvt_pk_bf16_f32 v66, v4, v5
    v_cvt_pk_bf16_f32 v67, v6, v7
    v_cvt_pk_bf16_f32 v68, v8, v9
    v_cvt_pk_bf16_f32 v69, v10, v11
    v_cvt_pk_bf16_f32 v70, v12, v13
    v_cvt_pk_bf16_f32 v71, v14, v15
    v_cndmask_b32 v70, v70, 0, s[60:61]
    v_cndmask_b32 v71, v71, 0, s[60:61]
    buffer_store_dwordx4 v[64:67], v250, s[12:15], s90 offen sc1
    buffer_store_dwordx4 v[68:71], v250, s[12:15], s90 offen offset:1024 sc1
    s_add_u32 s85, s33, 16384
    buffer_load_dwordx4 v[200:203], v250, s[12:15], s85 offen offset:2048 sc1
    s_add_u32 s85, s33, 16384
    buffer_load_dwordx4 v[204:207], v250, s[12:15], s85 offen offset:3072 sc1
    v_lshrrev_b32 v242, 4, v241
    s_lshl_b32 s3, s66, 3
    v_add_u32 v242, s3, v242
    v_xor_b32 v243, v242, v241
    v_and_b32 v243, 15, v243
    v_mul_u32_u24 v242, 896, v242
    v_xor_b32 v244, 4, v243
    v_min_u32 v243, 13, v243
    v_min_u32 v244, 13, v244
    v_lshl_add_u32 v243, v243, 4, v242
    v_lshl_add_u32 v244, v244, 4, v242
    v_add_u32 v244, 2560, v244
    s_mul_i32 s3, s75, 28672
    s_mul_i32 s80, s76, 224
    s_add_u32 s3, s3, s80
    s_add_u32 m0, s69, 17408
    s_nop 0
    buffer_load_dwordx4 v243, s[4:7], s3 offen lds
    buffer_load_dwordx4 v244, s[4:7], s3 offen offset:1024 lds
    s_add_u32 s85, s33, 20480
    buffer_load_dwordx4 v[208:211], v250, s[12:15], s85 offen offset:0 sc1
    s_add_u32 s85, s33, 20480
    buffer_load_dwordx4 v[212:215], v250, s[12:15], s85 offen offset:1024 sc1
    v_lshrrev_b32 v242, 3, v241
    v_mul_u32_u24 v242, 4096, v242
    v_and_b32 v243, 7, v241
    v_lshlrev_b32 v244, 2, v249
    v_xor_b32 v243, v243, v244
    v_lshl_add_u32 v92, v243, 4, v242
    v_add_u32 v93, 31744, v92
    v_add_u32 v94, 31744, v93
    v_add_u32 v95, 31744, v94
    v_lshl_add_u32 v242, v246, 2, v247
    v_lshlrev_b32 v242, 7, v242
    v_lshrrev_b32 v243, 1, v247
    v_xor_b32 v243, s16, v243
    v_lshl_add_u32 v242, v243, 6, v242
    v_lshl_add_u32 v242, v249, 5, v242
    v_lshl_add_u32 v242, v248, 3, v242
    v_add_u32 v96, s69, v242
    v_xor_b32 v97, 64, v96
    s_add_u32 s85, s33, 20480
    buffer_load_dwordx4 v[216:219], v250, s[12:15], s85 offen offset:2048 sc1
    s_add_u32 s85, s33, 20480
    buffer_load_dwordx4 v[220:223], v250, s[12:15], s85 offen offset:3072 sc1
    v_lshrrev_b32 v242, 3, v245
    v_mul_u32_u24 v242, 40960, v242
    v_and_b32 v243, 7, v245
    v_lshl_add_u32 v242, v243, 8, v242
    v_lshl_add_u32 v242, v246, 3, v242
    v_add_u32 v242, 17408, v242
    s_mul_i32 s3, s76, 7
    s_sub_u32 s3, s77, s3
    s_lshl_b32 s3, s3, 1
    v_and_b32 v243, 15, v245
    s_add_u32 s78, s3, 0
    v_xor_b32 v244, s78, v243
    v_lshl_add_u32 v80, v244, 4, v242
    s_add_u32 s78, s3, 1
    v_xor_b32 v244, s78, v243
    v_lshl_add_u32 v81, v244, 4, v242
    s_add_u32 s78, s3, 2
    v_xor_b32 v244, s78, v243
    v_lshl_add_u32 v82, v244, 4, v242
    s_add_u32 s78, s3, 3
    v_xor_b32 v244, s78, v243
    v_lshl_add_u32 v83, v244, 4, v242
    s_add_u32 s85, s33, 24576
    buffer_load_dwordx4 v[224:227], v250, s[12:15], s85 offen offset:0 sc1
    s_add_u32 s85, s33, 24576
    buffer_load_dwordx4 v[228:231], v250, s[12:15], s85 offen offset:1024 sc1
    s_add_u32 s85, s33, 24576
    buffer_load_dwordx4 v[232:235], v250, s[12:15], s85 offen offset:2048 sc1
    s_add_u32 s85, s33, 24576
    buffer_load_dwordx4 v[236:239], v250, s[12:15], s85 offen offset:3072 sc1
    s_add_u32 s85, s33, 28672
    buffer_load_dwordx4 v[112:115], v250, s[12:15], s85 offen offset:0 sc1
    s_add_u32 s85, s33, 28672
    buffer_load_dwordx4 v[116:119], v250, s[12:15], s85 offen offset:1024 sc1
    s_add_u32 s85, s33, 28672
    buffer_load_dwordx4 v[120:123], v250, s[12:15], s85 offen offset:2048 sc1
    s_add_u32 s85, s33, 28672
    buffer_load_dwordx4 v[124:127], v250, s[12:15], s85 offen offset:3072 sc1
    v_lshlrev_b32 v243, 3, v246
    s_lshl_b32 s3, s73, 1
    s_add_u32 s3, s3, s17
    s_lshl_b32 s3, s3, 6
    buffer_load_dwordx2 v[100:101], v243, s[52:55], s3 offen offset:0
    buffer_load_dwordx2 v[102:103], v243, s[52:55], s3 offen offset:16
    buffer_load_dwordx2 v[104:105], v243, s[52:55], s3 offen offset:32
    buffer_load_dwordx2 v[106:107], v243, s[52:55], s3 offen offset:48
    v_min_u32 v98, 7, v241
    v_lshlrev_b32 v98, 10, v98
    s_lshl_b32 s3, s75, 2
    s_add_u32 s3, s3, s66
    s_lshl_b32 s8, s3, 13
    s_add_u32 s8, s8, 3145728
    s_add_u32 s9, s8, 4096
    ds_read_b64_tr_b16 a[48:49], v88 offset:32768
    ds_read_b64_tr_b16 a[50:51], v88 offset:33280
    ds_read_b64_tr_b16 a[52:53], v89 offset:32768
    ds_read_b64_tr_b16 a[54:55], v89 offset:33280
    ds_read_b64_tr_b16 a[56:57], v88 offset:34816
    ds_read_b64_tr_b16 a[58:59], v88 offset:35328
    ds_read_b64_tr_b16 a[60:61], v89 offset:34816
    ds_read_b64_tr_b16 a[62:63], v89 offset:35328
    ds_read_b64_tr_b16 a[176:177], v88 offset:36864
    ds_read_b64_tr_b16 a[178:179], v88 offset:37376
    ds_read_b64_tr_b16 a[180:181], v89 offset:36864
    ds_read_b64_tr_b16 a[182:183], v89 offset:37376
    ds_read_b64_tr_b16 a[184:185], v88 offset:38912
    ds_read_b64_tr_b16 a[186:187], v88 offset:39424
    ds_read_b64_tr_b16 a[188:189], v89 offset:38912
    ds_read_b64_tr_b16 a[190:191], v89 offset:39424
    ds_read_b64_tr_b16 a[64:65], v88 offset:12288
    ds_read_b64_tr_b16 a[66:67], v88 offset:12800
    ds_read_b64_tr_b16 a[68:69], v89 offset:12288
    ds_read_b64_tr_b16 a[70:71], v89 offset:12800
    ds_read_b64_tr_b16 a[72:73], v88 offset:14336
    ds_read_b64_tr_b16 a[74:75], v88 offset:14848
    ds_read_b64_tr_b16 a[76:77], v89 offset:14336
    ds_read_b64_tr_b16 a[78:79], v89 offset:14848
    ds_read_b64_tr_b16 a[192:193], v88 offset:8192
    ds_read_b64_tr_b16 a[194:195], v88 offset:8704
    ds_read_b64_tr_b16 a[196:197], v89 offset:8192
    ds_read_b64_tr_b16 a[198:199], v89 offset:8704
    ds_read_b64_tr_b16 a[200:201], v88 offset:10240
    ds_read_b64_tr_b16 a[202:203], v88 offset:10752
    ds_read_b64_tr_b16 a[204:205], v89 offset:10240
    ds_read_b64_tr_b16 a[206:207], v89 offset:10752
    s_add_u32 s21, s81, 5
    s_and_b32 s21, s21, s23
    s_lshr_b32 s63, s21, 1
    s_mul_i32 s63, s63, s24
    s_add_u32 s21, s21, s63
    s_mul_i32 s21, s21, s20
    s_add_u32 s21, s21, s86
    s_add_u32 m0, s69, 24576
    s_nop 0
    buffer_load_dwordx4 v84, s[40:43], s21 offen offset:0 lds
    buffer_load_dwordx4 v85, s[40:43], s21 offen offset:1024 lds
    buffer_load_dwordx4 v86, s[40:43], s21 offen offset:2048 lds
    buffer_load_dwordx4 v87, s[40:43], s21 offen offset:3072 lds
    s_mov_b32 s84, 40000
    buffer_load_dword v99, v98, s[12:15], s8 offen offset:1020 sc1
    s_add_u32 m0, s69, 0
    s_nop 0
    buffer_load_dwordx4 v250, s[12:15], s8 offen offset:0 sc1 lds
    buffer_load_dwordx4 v250, s[12:15], s8 offen offset:1024 sc1 lds
    buffer_load_dwordx4 v250, s[12:15], s8 offen offset:2048 sc1 lds
    buffer_load_dwordx4 v250, s[12:15], s8 offen offset:3072 sc1 lds
    s_add_u32 m0, s69, 4096
    s_nop 0
    buffer_load_dwordx4 v250, s[12:15], s9 offen offset:0 sc1 lds
    buffer_load_dwordx4 v250, s[12:15], s9 offen offset:1024 sc1 lds
    buffer_load_dwordx4 v250, s[12:15], s9 offen offset:2048 sc1 lds
    buffer_load_dwordx4 v250, s[12:15], s9 offen offset:3072 sc1 lds
    s_waitcnt vmcnt(8)
    v_cmp_eq_u32 vcc, -1, v99
    s_cbranch_vccnz OBS
OBS_R:
    s_waitcnt vmcnt(0)
    s_barrier
    ds_read_b128 v[16:19], v250 offset:0
    ds_read_b128 v[20:23], v250 offset:1024
    ds_read_b128 v[24:27], v250 offset:2048
    ds_read_b128 v[28:31], v250 offset:3072
    ds_read_b128 v[32:35], v250 offset:4096
    ds_read_b128 v[36:39], v250 offset:5120
    ds_read_b64 v[48:49], v80
    ds_read_b64 v[50:51], v81
    ds_read_b64 v[52:53], v82
    ds_read_b64 v[54:55], v83
    s_waitcnt lgkmcnt(9)
    v_mfma_f32_32x32x16_bf16 v[0:15], v[128:131], v[16:19], 0
    ds_read_b128 v[40:43], v250 offset:6144
    s_add_u32 s21, s81, 5
    s_and_b32 s21, s21, s23
    s_lshr_b32 s63, s21, 1
    s_mul_i32 s63, s63, s24
    s_add_u32 s21, s21, s63
    s_lshl_b32 s63, s22, 5
    s_add_u32 s21, s21, s63
    s_mul_i32 s21, s21, s20
    s_add_u32 s21, s21, s86
    s_add_u32 m0, s69, 28672
    s_nop 0
    buffer_load_dwordx4 v84, s[40:43], s21 offen offset:0 lds
    s_waitcnt lgkmcnt(9)
    v_mfma_f32_32x32x16_bf16 v[0:15], v[132:135], v[20:23], v[0:15]
    v_max_u32 v90, v16, v20
    ds_read_b128 v[44:47], v250 offset:7168
    s_waitcnt lgkmcnt(9)
    v_mfma_f32_32x32x16_bf16 v[0:15], v[136:139], v[24:27], v[0:15]
    ds_read_b128 v[16:19], v250 offset:40960
    buffer_load_dwordx4 v85, s[40:43], s21 offen offset:1024 lds
    s_waitcnt lgkmcnt(9)
    v_mfma_f32_32x32x16_bf16 v[0:15], v[140:143], v[28:31], v[0:15]
    v_max3_u32 v90, v90, v24, v28
    ds_read_b128 v[20:23], v250 offset:41984
    s_waitcnt lgkmcnt(9)
    v_mfma_f32_32x32x16_bf16 v[0:15], v[144:147], v[32:35], v[0:15]
    ds_read_b128 v[24:27], v250 offset:43008
    buffer_load_dwordx4 v86, s[40:43], s21 offen offset:2048 lds
    s_waitcnt lgkmcnt(9)
    v_mfma_f32_32x32x16_bf16 v[0:15], v[148:151], v[36:39], v[0:15]
    v_max3_u32 v90, v90, v32, v36
    ds_read_b128 v[28:31], v250 offset:44032
    s_waitcnt lgkmcnt(5)
    v_mfma_f32_32x32x16_bf16 v[0:15], v[152:155], v[40:43], v[0:15]
    ds_read_b128 v[32:35], v250 offset:45056
    buffer_load_dwordx4 v87, s[40:43], s21 offen offset:3072 lds
    s_waitcnt lgkmcnt(5)
    v_mfma_f32_32x32x16_bf16 v[0:15], v[156:159], v[44:47], v[0:15]
    v_max3_u32 v90, v90, v40, v44
    ds_read_b128 v[36:39], v250 offset:46080
    s_waitcnt lgkmcnt(5)
    v_mfma_f32_32x32x16_bf16 v[0:15], v[160:163], v[16:19], v[0:15]
    ds_read_b128 v[40:43], v250 offset:47104
    s_add_u32 s21, s81, 6
    s_and_b32 s21, s21, s23
    s_lshr_b32 s63, s21, 1
    s_mul_i32 s63, s63, s24
    s_add_u32 s21, s21, s63
    s_mul_i32 s21, s21, s20
    s_add_u32 s21, s21, s86
    s_add_u32 m0, s69, 20480
    s_nop 0
    buffer_load_dwordx4 v84, s[40:43], s21 offen offset:0 lds
    s_waitcnt lgkmcnt(5)
    v_mfma_f32_32x32x16_bf16 v[0:15], v[164:167], v[20:23], v[0:15]
    v_max3_u32 v90, v90, v16, v20
    ds_read_b128 v[44:47], v250 offset:48128
    s_waitcnt lgkmcnt(5)
    v_mfma_f32_32x32x16_bf16 v[0:15], v[168:171], v[24:27], v[0:15]
    ds_read_b128 v[16:19], v254 offset:0
    buffer_load_dwordx4 v85, s[40:43], s21 offen offset:1024 lds
    s_waitcnt lgkmcnt(5)
    v_mfma_f32_32x32x16_bf16 v[0:15], v[172:175], v[28:31], v[0:15]
    v_max3_u32 v90, v90, v24, v28
    ds_read_b128 v[20:23], v254 offset:1024
    s_waitcnt lgkmcnt(5)
    v_mfma_f32_32x32x16_bf16 v[0:15], v[176:179], v[32:35], v[0:15]
    ds_read_b128 v[24:27], v254 offset:2048
    buffer_load_dwordx4 v86, s[40:43], s21 offen offset:2048 lds
    s_waitcnt lgkmcnt(5)
    v_mfma_f32_32x32x16_bf16 v[0:15], v[180:183], v[36:39], v[0:15]
    v_max3_u32 v90, v90, v32, v36
    ds_read_b128 v[28:31], v254 offset:3072
    s_waitcnt lgkmcnt(5)
    v_mfma_f32_32x32x16_bf16 v[0:15], v[184:187], v[40:43], v[0:15]
    ds_read_b128 v[32:35], v254 offset:4096
    buffer_load_dwordx4 v87, s[40:43], s21 offen offset:3072 lds
    s_waitcnt lgkmcnt(5)
    v_mfma_f32_32x32x16_bf16 v[0:15], v[188:191], v[44:47], v[0:15]
    v_max3_u32 v90, v90, v40, v44
    ds_read_b128 v[36:39], v254 offset:5120
    s_waitcnt lgkmcnt(5)
    v_mfma_f32_32x32x16_bf16 v[0:15], v[192:195], v[16:19], v[0:15]
    ds_read_b128 v[40:43], v254 offset:6144
    s_add_u32 s21, s81, 6
    s_and_b32 s21, s21, s23
    s_lshr_b32 s63, s21, 1
    s_mul_i32 s63, s63, s24
    s_add_u32 s21, s21, s63
    s_lshl_b32 s63, s22, 5
    s_add_u32 s21, s21, s63
    s_mul_i32 s21, s21, s20
    s_add_u32 s21, s21, s86
    s_add_u32 m0, s69, 32768
    s_nop 0
    buffer_load_dwordx4 v84, s[40:43], s21 offen offset:0 lds
    s_waitcnt lgkmcnt(5)
    v_mfma_f32_32x32x16_bf16 v[0:15], v[196:199], v[20:23], v[0:15]
    v_max3_u32 v90, v90, v16, v20
    ds_read_b128 v[44:47], v254 offset:7168
    s_waitcnt lgkmcnt(5)
    v_mfma_f32_32x32x16_bf16 v[0:15], v[200:203], v[24:27], v[0:15]
    ds_read_b128 v[16:19], v254 offset:40960
    buffer_load_dwordx4 v85, s[40:43], s21 offen offset:1024 lds
    s_waitcnt lgkmcnt(5)
    v_mfma_f32_32x32x16_bf16 v[0:15], v[204:207], v[28:31], v[0:15]
    v_max3_u32 v90, v90, v24, v28
    ds_read_b128 v[20:23], v254 offset:41984
    s_waitcnt lgkmcnt(5)
    v_mfma_f32_32x32x16_bf16 v[0:15], v[208:211], v[32:35], v[0:15]
    ds_read_b128 v[24:27], v254 offset:43008
    buffer_load_dwordx4 v86, s[40:43], s21 offen offset:2048 lds
    s_waitcnt lgkmcnt(5)
    v_mfma_f32_32x32x16_bf16 v[0:15], v[212:215], v[36:39], v[0:15]
    v_max3_u32 v90, v90, v32, v36
    ds_read_b128 v[28:31], v254 offset:44032
    s_waitcnt lgkmcnt(5)
    v_mfma_f32_32x32x16_bf16 v[0:15], v[216:219], v[40:43], v[0:15]
    ds_read_b128 v[32:35], v254 offset:45056
    buffer_load_dwordx4 v87, s[40:43], s21 offen offset:3072 lds
    s_waitcnt lgkmcnt(5)
    v_mfma_f32_32x32x16_bf16 v[0:15], v[220:223], v[44:47], v[0:15]
    v_max3_u32 v90, v90, v40, v44
    ds_read_b128 v[36:39], v254 offset:46080
    s_waitcnt lgkmcnt(5)
    v_mfma_f32_32x32x16_bf16 v[0:15], v[224:227], v[16:19], v[0:15]
    ds_read_b128 v[40:43], v254 offset:47104
    s_add_u32 s21, s81, 7
    s_and_b32 s21, s21, s23
    s_lshr_b32 s63, s21, 1
    s_mul_i32 s63, s63, s24
    s_add_u32 s21, s21, s63
    s_mul_i32 s21, s21, s20
    s_add_u32 s21, s21, s86
    s_add_u32 m0, s69, 36864
    s_nop 0
    buffer_load_dwordx4 v84, s[40:43], s21 offen offset:0 lds
    s_waitcnt lgkmcnt(5)
    v_mfma_f32_32x32x16_bf16 v[0:15], v[228:231], v[20:23], v[0:15]
    v_max3_u32 v90, v90, v16, v20
    ds_read_b128 v[44:47], v254 offset:48128
    s_waitcnt lgkmcnt(5)
    v_mfma_f32_32x32x16_bf16 v[0:15], v[232:235], v[24:27], v[0:15]
    buffer_load_dwordx4 v85, s[40:43], s21 offen offset:1024 lds
    s_waitcnt lgkmcnt(4)
    v_mfma_f32_32x32x16_bf16 v[0:15], v[236:239], v[28:31], v[0:15]
    v_max3_u32 v90, v90, v24, v28
    s_waitcnt lgkmcnt(3)
    v_mfma_f32_32x32x16_bf16 v[0:15], v[112:115], v[32:35], v[0:15]
    buffer_load_dwordx4 v86, s[40:43], s21 offen offset:2048 lds
    s_waitcnt lgkmcnt(2)
    v_mfma_f32_32x32x16_bf16 v[0:15], v[116:119], v[36:39], v[0:15]
    v_max3_u32 v90, v90, v32, v36
    s_waitcnt lgkmcnt(1)
    v_mfma_f32_32x32x16_bf16 v[0:15], v[120:123], v[40:43], v[0:15]
    buffer_load_dwordx4 v87, s[40:43], s21 offen offset:3072 lds
    s_waitcnt lgkmcnt(0)
    v_mfma_f32_32x32x16_bf16 v[0:15], v[124:127], v[44:47], v[0:15]
    v_max3_u32 v90, v90, v40, v44
    v_cmp_eq_u32 vcc, -1, v90
    s_cbranch_vccnz OBX
    v_lshlrev_b32 v16, 16, v48
    v_and_b32 v17, 0xffff0000, v48
    v_lshlrev_b32 v18, 16, v49
    v_and_b32 v19, 0xffff0000, v49
    v_lshlrev_b32 v20, 16, v50
    v_and_b32 v21, 0xffff0000, v50
    v_lshlrev_b32 v22, 16, v51
    v_and_b32 v23, 0xffff0000, v51
    v_lshlrev_b32 v24, 16, v52
    v_and_b32 v25, 0xffff0000, v52
    v_lshlrev_b32 v26, 16, v53
    v_and_b32 v27, 0xffff0000, v53
    v_lshlrev_b32 v28, 16, v54
    v_and_b32 v29, 0xffff0000, v54
    v_lshlrev_b32 v30, 16, v55
    v_and_b32 v31, 0xffff0000, v55
    s_cmp_eq_u32 s66, 3
    s_cselect_b32 s8, 0, 1.0
    s_mov_b32 s9, s8
    v_lshlrev_b32 v242, 4, v245
    s_lshl_b32 s10, s75, 13
    s_add_u32 s10, s10, 786432
    s_lshl_b32 s3, s76, 2
    s_add_u32 s3, s3, s66
    s_lshl_b32 s3, s3, 9
    s_add_u32 s79, s10, s3
    v_pk_add_f32 v[0:1], v[0:1], v[16:17]
    v_pk_add_f32 v[2:3], v[2:3], v[18:19]
    v_pk_add_f32 v[4:5], v[4:5], v[20:21]
    v_pk_add_f32 v[6:7], v[6:7], v[22:23]
    v_pk_add_f32 v[8:9], v[8:9], v[24:25]
    v_pk_add_f32 v[10:11], v[10:11], v[26:27]
    v_pk_add_f32 v[12:13], v[12:13], v[28:29]
    v_pk_add_f32 v[14:15], v[14:15], v[30:31]
    v_pk_add_f32 v[36:37], v[0:1], v[2:3]
    v_pk_add_f32 v[38:39], v[8:9], v[10:11]
    v_pk_mul_f32 v[40:41], v[0:1], v[0:1]
    v_pk_mul_f32 v[42:43], v[8:9], v[8:9]
    v_pk_add_f32 v[36:37], v[36:37], v[4:5]
    v_pk_add_f32 v[38:39], v[38:39], v[12:13]
    v_pk_add_f32 v[36:37], v[36:37], v[6:7]
    v_pk_add_f32 v[38:39], v[38:39], v[14:15]
    v_pk_fma_f32 v[40:41], v[2:3], v[2:3], v[40:41]
    v_pk_fma_f32 v[42:43], v[10:11], v[10:11], v[42:43]
    v_pk_fma_f32 v[40:41], v[4:5], v[4:5], v[40:41]
    v_pk_fma_f32 v[42:43], v[12:13], v[12:13], v[42:43]
    v_pk_fma_f32 v[40:41], v[6:7], v[6:7], v[40:41]
    v_pk_fma_f32 v[42:43], v[14:15], v[14:15], v[42:43]
    v_pk_fma_f32 v[36:37], v[36:37], s[8:9], v[38:39]
    v_pk_fma_f32 v[40:41], v[40:41], s[8:9], v[42:43]
    v_add_f32 v32, v36, v37
    v_add_f32 v33, v40, v41
    v_mov_b32 v36, v32
    v_mov_b32 v40, v33
    v_mov_b32 v34, s67
    v_mov_b32 v35, s68
    v_permlane32_swap_b32 v36, v32
    v_permlane32_swap_b32 v40, v33
    v_add_f32 v32, v32, v36
    v_add_f32 v33, v33, v40
    buffer_store_dwordx4 v[32:35], v242, s[12:15], s79 offen sc1
    v_lshl_add_u32 v120, v246, 12, v242
    s_or_b32 s3, s76, s66
    s_cselect_b32 s3, 0x10000000, 0
    v_add_u32 v121, s3, v242
    s_lshl_b32 s8, s75, 9
    s_add_u32 s8, s8, 9437184
    s_xor_b32 s3, s66, 1
    s_mul_i32 s3, s3, 40960
    s_add_u32 s3, s3, 0
    v_add_u32 v114, s3, v250
    s_add_u32 s21, s81, 7
    s_and_b32 s21, s21, s23
    s_lshr_b32 s63, s21, 1
    s_mul_i32 s63, s63, s24
    s_add_u32 s21, s21, s63
    s_lshl_b32 s63, s22, 5
    s_add_u32 s21, s21, s63
    s_mul_i32 s21, s21, s20
    s_add_u32 s21, s21, s86
    s_add_u32 m0, s69, 12288
    s_nop 0
    buffer_load_dwordx4 v84, s[40:43], s21 offen offset:0 lds
    buffer_load_dwordx4 v85, s[40:43], s21 offen offset:1024 lds
    buffer_load_dwordx4 v86, s[40:43], s21 offen offset:2048 lds
    buffer_load_dwordx4 v87, s[40:43], s21 offen offset:3072 lds
    s_xor_b32 s3, s66, 2
    s_mul_i32 s3, s3, 40960
    s_add_u32 s3, s3, 4096
    v_add_u32 v115, s3, v250
    ds_read_b64_tr_b16 a[80:81], v88 offset:24576
    ds_read_b64_tr_b16 a[82:83], v88 offset:25088
    ds_read_b64_tr_b16 a[84:85], v89 offset:24576
    ds_read_b64_tr_b16 a[86:87], v89 offset:25088
    s_xor_b32 s3, s66, 3
    s_mul_i32 s3, s3, 40960
    s_add_u32 s3, s3, 8192
    v_add_u32 v116, s3, v250
    ds_read_b64_tr_b16 a[88:89], v88 offset:26624
    ds_read_b64_tr_b16 a[90:91], v88 offset:27136
    ds_read_b64_tr_b16 a[92:93], v89 offset:26624
    ds_read_b64_tr_b16 a[94:95], v89 offset:27136
    v_mov_b32 v243, 65536
    v_mad_u32_u24 v244, v249, v243, v255
    s_mul_i32 s3, s16, 131072
    v_add_u32 v112, s3, v244
    s_xor_b32 s3, s16, 1
    s_mul_i32 s3, s3, 131072
    v_add_u32 v113, s3, v244
    s_waitcnt vmcnt(17)
    ds_read_b64_tr_b16 a[208:209], v88 offset:28672
    ds_read_b64_tr_b16 a[210:211], v88 offset:29184
    v_lshlrev_b32 v244, 3, v246
    v_add_u32 v244, s69, v244
    v_mov_b32 v243, 72
    v_mad_u32_u24 v117, v245, v243, v244
    v_lshl_add_u32 v118, v246, 3, v247
    v_lshl_add_u32 v244, v249, 2, v248
    v_lshlrev_b32 v244, 3, v244
    v_add_u32 v244, s69, v244
    v_mad_u32_u24 v118, v118, v243, v244
    v_lshl_add_u32 v119, v249, 16, v255
    ds_read_b64_tr_b16 a[212:213], v89 offset:28672
    ds_read_b64_tr_b16 a[214:215], v89 offset:29184
    ds_read_b64_tr_b16 a[216:217], v88 offset:30720
    ds_read_b64_tr_b16 a[218:219], v88 offset:31232
    ds_read_b64_tr_b16 a[220:221], v89 offset:30720
    ds_read_b64_tr_b16 a[222:223], v89 offset:31232
    s_waitcnt vmcnt(13)
    ds_read_b64_tr_b16 a[96:97], v88 offset:20480
    ds_read_b64_tr_b16 a[98:99], v88 offset:20992
    ds_read_b64_tr_b16 a[100:101], v89 offset:20480
    ds_read_b64_tr_b16 a[102:103], v89 offset:20992
    ds_read_b64_tr_b16 a[104:105], v88 offset:22528
    ds_read_b64_tr_b16 a[106:107], v88 offset:23040
    ds_read_b64_tr_b16 a[108:109], v89 offset:22528
    ds_read_b64_tr_b16 a[110:111], v89 offset:23040
    s_waitcnt vmcnt(9)
    ds_read_b64_tr_b16 a[224:225], v88 offset:32768
    ds_read_b64_tr_b16 a[226:227], v88 offset:33280
    ds_read_b64_tr_b16 a[228:229], v89 offset:32768
    ds_read_b64_tr_b16 a[230:231], v89 offset:33280
    ds_read_b64_tr_b16 a[232:233], v88 offset:34816
    ds_read_b64_tr_b16 a[234:235], v88 offset:35328
    ds_read_b64_tr_b16 a[236:237], v89 offset:34816
    ds_read_b64_tr_b16 a[238:239], v89 offset:35328
    v_add_u32 v122, 32768, v112
    v_add_u32 v123, 32768, v113
    s_lshl_b32 s3, s92, 7
    s_add_u32 s3, s3, s66
    s_lshl_b32 s78, s3, 11
    s_add_u32 s78, s78, 5242880
    s_add_u32 s3, s81, 0
    s_and_b32 s79, s3, 6
    s_and_b32 s3, s3, 1
    s_lshl2_add_u32 s3, s79, s3
    s_lshl_b32 s3, s3, 10
    s_add_u32 s25, s78, s3
    s_add_u32 s3, s81, 1
    s_and_b32 s79, s3, 6
    s_and_b32 s3, s3, 1
    s_lshl2_add_u32 s3, s79, s3
    s_lshl_b32 s3, s3, 10
    s_add_u32 s26, s78, s3
    s_add_u32 s3, s81, 2
    s_and_b32 s79, s3, 6
    s_and_b32 s3, s3, 1
    s_lshl2_add_u32 s3, s79, s3
    s_lshl_b32 s3, s3, 10
    s_add_u32 s27, s78, s3
    s_add_u32 s3, s81, 3
    s_and_b32 s79, s3, 6
    s_and_b32 s3, s3, 1
    s_lshl2_add_u32 s3, s79, s3
    s_lshl_b32 s3, s3, 10
    s_add_u32 s28, s78, s3
    s_add_u32 s3, s81, 4
    s_and_b32 s79, s3, 6
    s_and_b32 s3, s3, 1
    s_lshl2_add_u32 s3, s79, s3
    s_lshl_b32 s3, s3, 10
    s_add_u32 s29, s78, s3
    s_add_u32 s3, s81, 5
    s_and_b32 s79, s3, 6
    s_and_b32 s3, s3, 1
    s_lshl2_add_u32 s3, s79, s3
    s_lshl_b32 s3, s3, 10
    s_add_u32 s30, s78, s3
    s_add_u32 s3, s81, 6
    s_and_b32 s79, s3, 6
    s_and_b32 s3, s3, 1
    s_lshl2_add_u32 s3, s79, s3
    s_lshl_b32 s3, s3, 10
    s_add_u32 s31, s78, s3
    s_add_u32 s3, s81, 7
    s_and_b32 s79, s3, 6
    s_and_b32 s3, s3, 1
    s_lshl2_add_u32 s3, s79, s3
    s_lshl_b32 s3, s3, 10
    s_add_u32 s32, s78, s3
    s_add_u32 s18, s18, 5242880
    s_mov_b32 s84, 40000
    s_sleep 10
    buffer_load_dwordx4 v[128:131], v120, s[12:15], s10 offen offset:0 sc1
    buffer_load_dwordx4 v[132:135], v120, s[12:15], s10 offen offset:512 sc1
    buffer_load_dwordx4 v[136:139], v120, s[12:15], s10 offen offset:1024 sc1
    buffer_load_dwordx4 v[140:143], v120, s[12:15], s10 offen offset:1536 sc1
    buffer_load_dwordx4 v[144:147], v120, s[12:15], s10 offen offset:2048 sc1
    buffer_load_dwordx4 v[148:151], v120, s[12:15], s10 offen offset:2560 sc1
    buffer_load_dwordx4 v[152:155], v120, s[12:15], s10 offen offset:3072 sc1
    buffer_load_dwordx4 v[156:159], v120, s[12:15], s10 offen offset:3584 sc1
    s_waitcnt vmcnt(13)
    ds_read_b64_tr_b16 a[112:113], v88 offset:36864
    ds_read_b64_tr_b16 a[114:115], v88 offset:37376
    ds_read_b64_tr_b16 a[116:117], v89 offset:36864
    ds_read_b64_tr_b16 a[118:119], v89 offset:37376
    ds_read_b64_tr_b16 a[120:121], v88 offset:38912
    ds_read_b64_tr_b16 a[122:123], v88 offset:39424
    ds_read_b64_tr_b16 a[124:125], v89 offset:38912
    ds_read_b64_tr_b16 a[126:127], v89 offset:39424
    s_waitcnt vmcnt(8)
    ds_read_b64_tr_b16 a[240:241], v88 offset:12288
    ds_read_b64_tr_b16 a[242:243], v88 offset:12800
    ds_read_b64_tr_b16 a[244:245], v89 offset:12288
    ds_read_b64_tr_b16 a[246:247], v89 offset:12800
    ds_read_b64_tr_b16 a[248:249], v88 offset:14336
    ds_read_b64_tr_b16 a[250:251], v88 offset:14848
    ds_read_b64_tr_b16 a[252:253], v89 offset:14336
    ds_read_b64_tr_b16 a[254:255], v89 offset:14848
    s_waitcnt vmcnt(0)
STP:
    v_xor_b32 v244, s67, v130
    v_bitop3_b32 v244, s68, v131, v244 bitop3:0xbe
    v_bitop3_b32 v244, s67, v134, v244 bitop3:0xbe
    v_bitop3_b32 v244, s68, v135, v244 bitop3:0xbe
    v_bitop3_b32 v244, s67, v138, v244 bitop3:0xbe
    v_bitop3_b32 v244, s68, v139, v244 bitop3:0xbe
    v_bitop3_b32 v244, s67, v142, v244 bitop3:0xbe
    v_bitop3_b32 v244, s68, v143, v244 bitop3:0xbe
    v_bitop3_b32 v244, s67, v146, v244 bitop3:0xbe
    v_bitop3_b32 v244, s68, v147, v244 bitop3:0xbe
    v_bitop3_b32 v244, s67, v150, v244 bitop3:0xbe
    v_bitop3_b32 v244, s68, v151, v244 bitop3:0xbe
    v_bitop3_b32 v244, s67, v154, v244 bitop3:0xbe
    v_bitop3_b32 v244, s68, v155, v244 bitop3:0xbe
    v_bitop3_b32 v244, s67, v158, v244 bitop3:0xbe
    v_bitop3_b32 v244, s68, v159, v244 bitop3:0xbe
    v_cmp_ne_u32 vcc, 0, v244
    s_cbranch_vccnz STS
    v_pk_add_f32 v[128:129], v[128:129], v[132:133]
    v_pk_add_f32 v[136:137], v[136:137], v[140:141]
    v_pk_add_f32 v[144:145], v[144:145], v[148:149]
    v_pk_add_f32 v[152:153], v[152:153], v[156:157]
    v_pk_add_f32 v[128:129], v[128:129], v[136:137]
    v_pk_add_f32 v[144:145], v[144:145], v[152:153]
    v_pk_add_f32 v[128:129], v[128:129], v[144:145]
    v_mov_b32 v130, v128
    v_mov_b32 v131, v129
    s_nop 0
    v_permlane32_swap_b32 v128, v130
    v_permlane32_swap_b32 v129, v131
    v_pk_add_f32 v[128:129], v[128:129], v[130:131]
    v_mul_f32 v128, 0x3b124925, v128
    v_mul_f32 v129, 0x3b124925, v129
    v_fma_f32 v129, -v128, v128, v129
    v_max_f32 v129, 0, v129
    v_add_f32 v130, 0x3727c5ac, v129
    v_rcp_f32 v131, v130
    v_rsq_f32 v132, v130
    v_mov_b32 v134, 0x3727c5ac
    v_fma_f32 v131, v129, v131, v134
    v_rsq_f32 v131, v131
    s_nop 0
    v_mul_f32 v132, v132, v131
    v_mul_f32_e64 v134, -v128, v132
    v_rcp_f32 v129, v132
    v_pk_fma_f32 v[0:1], v[0:1], v[132:133], v[134:135] op_sel_hi:[1,0,0]
    v_pk_fma_f32 v[2:3], v[2:3], v[132:133], v[134:135] op_sel_hi:[1,0,0]
    v_pk_fma_f32 v[4:5], v[4:5], v[132:133], v[134:135] op_sel_hi:[1,0,0]
    v_pk_fma_f32 v[6:7], v[6:7], v[132:133], v[134:135] op_sel_hi:[1,0,0]
    v_pk_fma_f32 v[8:9], v[8:9], v[132:133], v[134:135] op_sel_hi:[1,0,0]
    v_pk_fma_f32 v[10:11], v[10:11], v[132:133], v[134:135] op_sel_hi:[1,0,0]
    v_pk_fma_f32 v[12:13], v[12:13], v[132:133], v[134:135] op_sel_hi:[1,0,0]
    v_pk_fma_f32 v[14:15], v[14:15], v[132:133], v[134:135] op_sel_hi:[1,0,0]
    v_cvt_pk_bf16_f32 v64, v0, v1
    v_cvt_pk_bf16_f32 v65, v2, v3
    v_cvt_pk_bf16_f32 v66, v4, v5
    v_cvt_pk_bf16_f32 v67, v6, v7
    v_cvt_pk_bf16_f32 v68, v8, v9
    v_cvt_pk_bf16_f32 v69, v10, v11
    v_cvt_pk_bf16_f32 v70, v12, v13
    v_cvt_pk_bf16_f32 v71, v14, v15
    ds_write_b64 v117, v[64:65] offset:16384
    ds_write_b64 v117, v[66:67] offset:16400
    ds_write_b64 v117, v[68:69] offset:16416
    ds_write_b64 v117, v[70:71] offset:16432
    s_waitcnt lgkmcnt(0)
    ds_read_b64_tr_b16 v[72:73], v118 offset:16384
    ds_read_b64_tr_b16 v[74:75], v118 offset:16672
    ds_read_b64_tr_b16 v[76:77], v118 offset:17536
    ds_read_b64_tr_b16 v[78:79], v118 offset:17824
    v_mov_b32 v130, s67
    v_mov_b32 v131, s68
    s_waitcnt lgkmcnt(0)
    buffer_store_dwordx4 v[72:75], v119, s[12:15], s18 offen sc1
    buffer_store_dwordx4 v[76:79], v119, s[12:15], s18 offen offset:512 sc1
    buffer_store_dwordx4 v[128:131], v121, s[12:15], s8 offen sc1
    s_cmp_ge_u32 s71, 28
    s_cbranch_scc1 IDLE
    s_add_u32 s21, s87, 0
    s_add_u32 m0, s69, 8192
    s_nop 0
    buffer_load_dwordx4 v92, s[44:47], s21 offen offset:0 lds
    buffer_load_dwordx4 v93, s[44:47], s21 offen offset:1024 lds
    buffer_load_dwordx4 v94, s[44:47], s21 offen offset:2048 lds
    buffer_load_dwordx4 v95, s[44:47], s21 offen offset:3072 lds
    s_add_u32 s21, s87, 131072
    s_add_u32 m0, s69, 24576
    s_nop 0
    buffer_load_dwordx4 v92, s[44:47], s21 offen offset:0 lds
    buffer_load_dwordx4 v93, s[44:47], s21 offen offset:1024 lds
    buffer_load_dwordx4 v94, s[44:47], s21 offen offset:2048 lds
    buffer_load_dwordx4 v95, s[44:47], s21 offen offset:3072 lds
    s_add_u32 s21, s87, 262144
    s_add_u32 m0, s69, 28672
    s_nop 0
    buffer_load_dwordx4 v92, s[44:47], s21 offen offset:0 lds
    buffer_load_dwordx4 v93, s[44:47], s21 offen offset:1024 lds
    buffer_load_dwordx4 v94, s[44:47], s21 offen offset:2048 lds
    buffer_load_dwordx4 v95, s[44:47], s21 offen offset:3072 lds
    s_add_u32 s21, s87, 393216
    s_add_u32 m0, s69, 20480
    s_nop 0
    buffer_load_dwordx4 v92, s[44:47], s21 offen offset:0 lds
    buffer_load_dwordx4 v93, s[44:47], s21 offen offset:1024 lds
    buffer_load_dwordx4 v94, s[44:47], s21 offen offset:2048 lds
    buffer_load_dwordx4 v95, s[44:47], s21 offen offset:3072 lds
    s_add_u32 s21, s87, 524288
    s_add_u32 m0, s69, 32768
    s_nop 0
    buffer_load_dwordx4 v92, s[44:47], s21 offen offset:0 lds
    buffer_load_dwordx4 v93, s[44:47], s21 offen offset:1024 lds
    buffer_load_dwordx4 v94, s[44:47], s21 offen offset:2048 lds
    buffer_load_dwordx4 v95, s[44:47], s21 offen offset:3072 lds
    s_add_u32 s21, s87, 655360
    s_add_u32 m0, s69, 36864
    s_nop 0
    buffer_load_dwordx4 v92, s[44:47], s21 offen offset:0 lds
    buffer_load_dwordx4 v93, s[44:47], s21 offen offset:1024 lds
    buffer_load_dwordx4 v94, s[44:47], s21 offen offset:2048 lds
    buffer_load_dwordx4 v95, s[44:47], s21 offen offset:3072 lds
    v_lshlrev_b32 v0, 16, v100
    v_and_b32 v1, 0xffff0000, v100
    v_lshlrev_b32 v2, 16, v101
    v_and_b32 v3, 0xffff0000, v101
    v_lshlrev_b32 v4, 16, v102
    v_and_b32 v5, 0xffff0000, v102
    v_lshlrev_b32 v6, 16, v103
    v_and_b32 v7, 0xffff0000, v103
    v_lshlrev_b32 v8, 16, v104
    v_and_b32 v9, 0xffff0000, v104
    v_lshlrev_b32 v10, 16, v105
    v_and_b32 v11, 0xffff0000, v105
    v_lshlrev_b32 v12, 16, v106
    v_and_b32 v13, 0xffff0000, v106
    v_lshlrev_b32 v14, 16, v107
    v_and_b32 v15, 0xffff0000, v107
    s_sleep 7
    s_mov_b32 s84, 40000
    buffer_load_dwordx4 v[128:131], v112, s[12:15], s25 offen offset:0 sc1
    buffer_load_dwordx4 v[132:135], v113, s[12:15], s25 offen offset:0 sc1
    buffer_load_dwordx4 v[136:139], v112, s[12:15], s25 offen offset:512 sc1
    buffer_load_dwordx4 v[140:143], v113, s[12:15], s25 offen offset:512 sc1
    buffer_load_dwordx4 v[144:147], v112, s[12:15], s26 offen offset:0 sc1
    buffer_load_dwordx4 v[148:151], v113, s[12:15], s26 offen offset:0 sc1
    buffer_load_dwordx4 v[152:155], v112, s[12:15], s26 offen offset:512 sc1
    buffer_load_dwordx4 v[156:159], v113, s[12:15], s26 offen offset:512 sc1
    buffer_load_dwordx4 v[160:163], v112, s[12:15], s27 offen offset:0 sc1
    buffer_load_dwordx4 v[164:167], v113, s[12:15], s27 offen offset:0 sc1
    buffer_load_dwordx4 v[168:171], v112, s[12:15], s27 offen offset:512 sc1
    buffer_load_dwordx4 v[172:175], v113, s[12:15], s27 offen offset:512 sc1
    s_waitcnt vmcnt(9)
    v_max3_u32 v90, v128, v132, v136
    s_waitcnt vmcnt(8)
    v_max3_u32 v90, v90, v140, v140
    v_cmp_eq_u32 vcc, -1, v90
    s_cbranch_vccnz G3S0
G3R0:
    v_mfma_f32_32x32x16_bf16 v[0:15], a[0:3], v[128:131], v[0:15]
    buffer_load_dwordx4 v[176:179], v112, s[12:15], s28 offen offset:0 sc1
    v_mfma_f32_32x32x16_bf16 v[32:47], a[4:7], v[128:131], 0
    buffer_load_dwordx4 v[180:183], v113, s[12:15], s28 offen offset:0 sc1
    v_mfma_f32_32x32x16_bf16 v[16:31], a[0:3], v[132:135], 0
    buffer_load_dwordx4 v[184:187], v112, s[12:15], s28 offen offset:512 sc1
    v_mfma_f32_32x32x16_bf16 v[48:63], a[4:7], v[132:135], 0
    buffer_load_dwordx4 v[188:191], v113, s[12:15], s28 offen offset:512 sc1
    v_mfma_f32_32x32x16_bf16 v[0:15], a[8:11], v[136:139], v[0:15]
    buffer_load_dwordx4 v[128:131], v112, s[12:15], s29 offen offset:0 sc1
    v_mfma_f32_32x32x16_bf16 v[32:47], a[12:15], v[136:139], v[32:47]
    buffer_load_dwordx4 v[132:135], v113, s[12:15], s29 offen offset:0 sc1
    v_mfma_f32_32x32x16_bf16 v[16:31], a[8:11], v[140:143], v[16:31]
    s_waitcnt vmcnt(11)
    v_max3_u32 v90, v144, v148, v152
    v_mfma_f32_32x32x16_bf16 v[48:63], a[12:15], v[140:143], v[48:63]
    buffer_load_dwordx4 v[136:139], v112, s[12:15], s29 offen offset:512 sc1
    s_waitcnt vmcnt(11)
    v_max3_u32 v90, v90, v156, v156
    ds_read_b64_tr_b16 a[0:1], v96 offset:8192
    v_cmp_eq_u32 vcc, -1, v90
    s_cbranch_vccnz G3S1
G3R1:
    v_mfma_f32_32x32x16_bf16 v[0:15], a[16:19], v[144:147], v[0:15]
    ds_read_b64_tr_b16 a[2:3], v96 offset:9216
    v_mfma_f32_32x32x16_bf16 v[32:47], a[20:23], v[144:147], v[32:47]
    buffer_load_dwordx4 v[140:143], v113, s[12:15], s29 offen offset:512 sc1
    s_add_u32 s21, s87, 786432
    s_add_u32 m0, s69, 12288
    s_nop 0
    buffer_load_dwordx4 v92, s[44:47], s21 offen offset:0 lds
    ds_read_b64_tr_b16 a[4:5], v97 offset:8192
    v_mfma_f32_32x32x16_bf16 v[16:31], a[16:19], v[148:151], v[16:31]
    ds_read_b64_tr_b16 a[6:7], v97 offset:9216
    v_mfma_f32_32x32x16_bf16 v[48:63], a[20:23], v[148:151], v[48:63]
    buffer_load_dwordx4 v[144:147], v112, s[12:15], s30 offen offset:0 sc1
    ds_read_b64_tr_b16 a[8:9], v96 offset:10240
    v_mfma_f32_32x32x16_bf16 v[0:15], a[24:27], v[152:155], v[0:15]
    buffer_load_dwordx4 v93, s[44:47], s21 offen offset:1024 lds
    ds_read_b64_tr_b16 a[10:11], v96 offset:11264
    v_mfma_f32_32x32x16_bf16 v[32:47], a[28:31], v[152:155], v[32:47]
    buffer_load_dwordx4 v[148:151], v113, s[12:15], s30 offen offset:0 sc1
    ds_read_b64_tr_b16 a[12:13], v97 offset:10240
    v_mfma_f32_32x32x16_bf16 v[16:31], a[24:27], v[156:159], v[16:31]
    s_waitcnt vmcnt(13)
    v_max3_u32 v90, v160, v164, v168
    ds_read_b64_tr_b16 a[14:15], v97 offset:11264
    v_mfma_f32_32x32x16_bf16 v[48:63], a[28:31], v[156:159], v[48:63]
    buffer_load_dwordx4 v[152:155], v112, s[12:15], s30 offen offset:512 sc1
    s_waitcnt vmcnt(13)
    v_max3_u32 v90, v90, v172, v172
    buffer_load_dwordx4 v94, s[44:47], s21 offen offset:2048 lds
    ds_read_b64_tr_b16 a[16:17], v96 offset:24576
    v_cmp_eq_u32 vcc, -1, v90
    s_cbranch_vccnz G3S2
G3R2:
    v_mfma_f32_32x32x16_bf16 v[0:15], a[32:35], v[160:163], v[0:15]
    ds_read_b64_tr_b16 a[18:19], v96 offset:25600
    v_mfma_f32_32x32x16_bf16 v[32:47], a[36:39], v[160:163], v[32:47]
    buffer_load_dwordx4 v[156:159], v113, s[12:15], s30 offen offset:512 sc1
    ds_read_b64_tr_b16 a[20:21], v97 offset:24576
    v_mfma_f32_32x32x16_bf16 v[16:31], a[32:35], v[164:167], v[16:31]
    s_add_u32 m0, s69, 12288
    s_nop 0
    buffer_load_dwordx4 v95, s[44:47], s21 offen offset:3072 lds
    ds_read_b64_tr_b16 a[22:23], v97 offset:25600
    v_mfma_f32_32x32x16_bf16 v[48:63], a[36:39], v[164:167], v[48:63]
    buffer_load_dwordx4 v[160:163], v112, s[12:15], s31 offen offset:0 sc1
    ds_read_b64_tr_b16 a[24:25], v96 offset:26624
    v_mfma_f32_32x32x16_bf16 v[0:15], a[40:43], v[168:171], v[0:15]
    ds_read_b64_tr_b16 a[26:27], v96 offset:27648
    v_mfma_f32_32x32x16_bf16 v[32:47], a[44:47], v[168:171], v[32:47]
    buffer_load_dwordx4 v[164:167], v113, s[12:15], s31 offen offset:0 sc1
    s_add_u32 s21, s87, 3670016
    s_add_u32 m0, s69, 16384
    s_nop 0
    buffer_load_dwordx4 v92, s[44:47], s21 offen offset:0 lds
    ds_read_b64_tr_b16 a[28:29], v97 offset:26624
    v_mfma_f32_32x32x16_bf16 v[16:31], a[40:43], v[172:175], v[16:31]
    s_waitcnt vmcnt(16)
    v_max3_u32 v90, v176, v180, v184
    ds_read_b64_tr_b16 a[30:31], v97 offset:27648
    v_mfma_f32_32x32x16_bf16 v[48:63], a[44:47], v[172:175], v[48:63]
    buffer_load_dwordx4 v[168:171], v112, s[12:15], s31 offen offset:512 sc1
    s_waitcnt vmcnt(16)
    v_max3_u32 v90, v90, v188, v188
    ds_read_b64_tr_b16 a[32:33], v96 offset:28672
    v_cmp_eq_u32 vcc, -1, v90
    s_cbranch_vccnz G3S3
G3R3:
    v_mfma_f32_32x32x16_bf16 v[0:15], a[48:51], v[176:179], v[0:15]
    s_add_u32 m0, s69, 16384
    s_nop 0
    buffer_load_dwordx4 v93, s[44:47], s21 offen offset:1024 lds
    ds_read_b64_tr_b16 a[34:35], v96 offset:29696
    v_mfma_f32_32x32x16_bf16 v[32:47], a[52:55], v[176:179], v[32:47]
    buffer_load_dwordx4 v[172:175], v113, s[12:15], s31 offen offset:512 sc1
    ds_read_b64_tr_b16 a[36:37], v97 offset:28672
    v_mfma_f32_32x32x16_bf16 v[16:31], a[48:51], v[180:183], v[16:31]
    ds_read_b64_tr_b16 a[38:39], v97 offset:29696
    v_mfma_f32_32x32x16_bf16 v[48:63], a[52:55], v[180:183], v[48:63]
    buffer_load_dwordx4 v[176:179], v112, s[12:15], s32 offen offset:0 sc1
    buffer_load_dwordx4 v94, s[44:47], s21 offen offset:2048 lds
    ds_read_b64_tr_b16 a[40:41], v96 offset:30720
    v_mfma_f32_32x32x16_bf16 v[0:15], a[56:59], v[184:187], v[0:15]
    ds_read_b64_tr_b16 a[42:43], v96 offset:31744
    v_mfma_f32_32x32x16_bf16 v[32:47], a[60:63], v[184:187], v[32:47]
    buffer_load_dwordx4 v[180:183], v113, s[12:15], s32 offen offset:0 sc1
    ds_read_b64_tr_b16 a[44:45], v97 offset:30720
    v_mfma_f32_32x32x16_bf16 v[16:31], a[56:59], v[188:191], v[16:31]
    s_waitcnt vmcnt(18)
    v_max3_u32 v90, v128, v132, v136
    buffer_load_dwordx4 v95, s[44:47], s21 offen offset:3072 lds
    ds_read_b64_tr_b16 a[46:47], v97 offset:31744
    v_mfma_f32_32x32x16_bf16 v[48:63], a[60:63], v[188:191], v[48:63]
    buffer_load_dwordx4 v[184:187], v112, s[12:15], s32 offen offset:512 sc1
    s_waitcnt vmcnt(19)
    v_max3_u32 v90, v90, v140, v140
    ds_read_b64_tr_b16 a[48:49], v96 offset:20480
    v_cmp_eq_u32 vcc, -1, v90
    s_cbranch_vccnz G3S4
G3R4:
    v_mfma_f32_32x32x16_bf16 v[0:15], a[64:67], v[128:131], v[0:15]
    ds_read_b64_tr_b16 a[50:51], v96 offset:21504
    v_mfma_f32_32x32x16_bf16 v[32:47], a[68:71], v[128:131], v[32:47]
    buffer_load_dwordx4 v[188:191], v113, s[12:15], s32 offen offset:512 sc1
    ds_read_b64_tr_b16 a[52:53], v97 offset:20480
    v_mfma_f32_32x32x16_bf16 v[16:31], a[64:67], v[132:135], v[16:31]
    ds_read_b64_tr_b16 a[54:55], v97 offset:21504
    v_mfma_f32_32x32x16_bf16 v[48:63], a[68:71], v[132:135], v[48:63]
    buffer_load_dwordx4 v[128:131], v122, s[12:15], s25 offen offset:0 sc1
    ds_read_b64_tr_b16 a[56:57], v96 offset:22528
    v_mfma_f32_32x32x16_bf16 v[0:15], a[72:75], v[136:139], v[0:15]
    ds_read_b64_tr_b16 a[58:59], v96 offset:23552
    v_mfma_f32_32x32x16_bf16 v[32:47], a[76:79], v[136:139], v[32:47]
    buffer_load_dwordx4 v[132:135], v123, s[12:15], s25 offen offset:0 sc1
    ds_read_b64_tr_b16 a[60:61], v97 offset:22528
    v_mfma_f32_32x32x16_bf16 v[16:31], a[72:75], v[140:143], v[16:31]
    s_waitcnt vmcnt(17)
    v_max3_u32 v90, v144, v148, v152
    ds_read_b64_tr_b16 a[62:63], v97 offset:23552
    v_mfma_f32_32x32x16_bf16 v[48:63], a[76:79], v[140:143], v[48:63]
    buffer_load_dwordx4 v[136:139], v122, s[12:15], s25 offen offset:512 sc1
    s_waitcnt vmcnt(16)
    v_max3_u32 v90, v90, v156, v156
    ds_read_b64_tr_b16 a[64:65], v96 offset:32768
    v_cmp_eq_u32 vcc, -1, v90
    s_cbranch_vccnz G3S5
G3R5:
    v_mfma_f32_32x32x16_bf16 v[0:15], a[80:83], v[144:147], v[0:15]
    ds_read_b64_tr_b16 a[66:67], v96 offset:33792
    v_mfma_f32_32x32x16_bf16 v[32:47], a[84:87], v[144:147], v[32:47]
    buffer_load_dwordx4 v[140:143], v123, s[12:15], s25 offen offset:512 sc1
    ds_read_b64_tr_b16 a[68:69], v97 offset:32768
    v_mfma_f32_32x32x16_bf16 v[16:31], a[80:83], v[148:151], v[16:31]
    ds_read_b64_tr_b16 a[70:71], v97 offset:33792
    v_mfma_f32_32x32x16_bf16 v[48:63], a[84:87], v[148:151], v[48:63]
    buffer_load_dwordx4 v[144:147], v122, s[12:15], s26 offen offset:0 sc1
    ds_read_b64_tr_b16 a[72:73], v96 offset:34816
    v_mfma_f32_32x32x16_bf16 v[0:15], a[88:91], v[152:155], v[0:15]
    ds_read_b64_tr_b16 a[74:75], v96 offset:35840
    v_mfma_f32_32x32x16_bf16 v[32:47], a[92:95], v[152:155], v[32:47]
    buffer_load_dwordx4 v[148:151], v123, s[12:15], s26 offen offset:0 sc1
    ds_read_b64_tr_b16 a[76:77], v97 offset:34816
    v_mfma_f32_32x32x16_bf16 v[16:31], a[88:91], v[156:159], v[16:31]
    s_waitcnt vmcnt(14)
    v_max3_u32 v90, v160, v164, v168
    ds_read_b64_tr_b16 a[78:79], v97 offset:35840
    v_mfma_f32_32x32x16_bf16 v[48:63], a[92:95], v[156:159], v[48:63]
    buffer_load_dwordx4 v[152:155], v122, s[12:15], s26 offen offset:512 sc1
    s_waitcnt vmcnt(13)
    v_max3_u32 v90, v90, v172, v172
    ds_read_b64_tr_b16 a[80:81], v96 offset:36864
    v_cmp_eq_u32 vcc, -1, v90
    s_cbranch_vccnz G3S6
G3R6:
    v_mfma_f32_32x32x16_bf16 v[0:15], a[96:99], v[160:163], v[0:15]
    ds_read_b64_tr_b16 a[82:83], v96 offset:37888
    v_mfma_f32_32x32x16_bf16 v[32:47], a[100:103], v[160:163], v[32:47]
    buffer_load_dwordx4 v[156:159], v123, s[12:15], s26 offen offset:512 sc1
    ds_read_b64_tr_b16 a[84:85], v97 offset:36864
    v_mfma_f32_32x32x16_bf16 v[16:31], a[96:99], v[164:167], v[16:31]
    ds_read_b64_tr_b16 a[86:87], v97 offset:37888
    v_mfma_f32_32x32x16_bf16 v[48:63], a[100:103], v[164:167], v[48:63]
    buffer_load_dwordx4 v[160:163], v122, s[12:15], s27 offen offset:0 sc1
    ds_read_b64_tr_b16 a[88:89], v96 offset:38912
    v_mfma_f32_32x32x16_bf16 v[0:15], a[104:107], v[168:171], v[0:15]
    ds_read_b64_tr_b16 a[90:91], v96 offset:39936
    v_mfma_f32_32x32x16_bf16 v[32:47], a[108:111], v[168:171], v[32:47]
    buffer_load_dwordx4 v[164:167], v123, s[12:15], s27 offen offset:0 sc1
    ds_read_b64_tr_b16 a[92:93], v97 offset:38912
    v_mfma_f32_32x32x16_bf16 v[16:31], a[104:107], v[172:175], v[16:31]
    s_waitcnt vmcnt(11)
    v_max3_u32 v90, v176, v180, v184
    ds_read_b64_tr_b16 a[94:95], v97 offset:39936
    v_mfma_f32_32x32x16_bf16 v[48:63], a[108:111], v[172:175], v[48:63]
    buffer_load_dwordx4 v[168:171], v122, s[12:15], s27 offen offset:512 sc1
    s_waitcnt vmcnt(11)
    v_max3_u32 v90, v90, v188, v188
    ds_read_b64_tr_b16 a[96:97], v96 offset:12288
    v_cmp_eq_u32 vcc, -1, v90
    s_cbranch_vccnz G3S7
G3R7:
    v_mfma_f32_32x32x16_bf16 v[0:15], a[112:115], v[176:179], v[0:15]
    ds_read_b64_tr_b16 a[98:99], v96 offset:13312
    v_mfma_f32_32x32x16_bf16 v[32:47], a[116:119], v[176:179], v[32:47]
    buffer_load_dwordx4 v[172:175], v123, s[12:15], s27 offen offset:512 sc1
    ds_read_b64_tr_b16 a[100:101], v97 offset:12288
    v_mfma_f32_32x32x16_bf16 v[16:31], a[112:115], v[180:183], v[16:31]
    ds_read_b64_tr_b16 a[102:103], v97 offset:13312
    v_mfma_f32_32x32x16_bf16 v[48:63], a[116:119], v[180:183], v[48:63]
    buffer_load_dwordx4 v[176:179], v122, s[12:15], s28 offen offset:0 sc1
    ds_read_b64_tr_b16 a[104:105], v96 offset:14336
    v_mfma_f32_32x32x16_bf16 v[0:15], a[120:123], v[184:187], v[0:15]
    ds_read_b64_tr_b16 a[106:107], v96 offset:15360
    v_mfma_f32_32x32x16_bf16 v[32:47], a[124:127], v[184:187], v[32:47]
    buffer_load_dwordx4 v[180:183], v123, s[12:15], s28 offen offset:0 sc1
    ds_read_b64_tr_b16 a[108:109], v97 offset:14336
    v_mfma_f32_32x32x16_bf16 v[16:31], a[120:123], v[188:191], v[16:31]
    s_waitcnt vmcnt(11)
    v_max3_u32 v90, v128, v132, v136
    ds_read_b64_tr_b16 a[110:111], v97 offset:15360
    v_mfma_f32_32x32x16_bf16 v[48:63], a[124:127], v[188:191], v[48:63]
    buffer_load_dwordx4 v[184:187], v122, s[12:15], s28 offen offset:512 sc1
    s_waitcnt vmcnt(11)
    v_max3_u32 v90, v90, v140, v140
    ds_read_b64_tr_b16 a[112:113], v96 offset:16384
    v_cmp_eq_u32 vcc, -1, v90
    s_cbranch_vccnz G3S8
G3R8:
    v_mfma_f32_32x32x16_bf16 v[0:15], a[128:131], v[128:131], v[0:15]
    ds_read_b64_tr_b16 a[114:115], v96 offset:17408
    v_mfma_f32_32x32x16_bf16 v[32:47], a[132:135], v[128:131], v[32:47]
    buffer_load_dwordx4 v[188:191], v123, s[12:15], s28 offen offset:512 sc1
    ds_read_b64_tr_b16 a[116:117], v97 offset:16384
    v_mfma_f32_32x32x16_bf16 v[16:31], a[128:131], v[132:135], v[16:31]
    ds_read_b64_tr_b16 a[118:119], v97 offset:17408
    v_mfma_f32_32x32x16_bf16 v[48:63], a[132:135], v[132:135], v[48:63]
    buffer_load_dwordx4 v[128:131], v123, s[12:15], s29 offen offset:0 sc1
    ds_read_b64_tr_b16 a[120:121], v96 offset:18432
    v_mfma_f32_32x32x16_bf16 v[0:15], a[136:139], v[136:139], v[0:15]
    ds_read_b64_tr_b16 a[122:123], v96 offset:19456
    v_mfma_f32_32x32x16_bf16 v[32:47], a[140:143], v[136:139], v[32:47]
    buffer_load_dwordx4 v[132:135], v123, s[12:15], s29 offen offset:512 sc1
    ds_read_b64_tr_b16 a[124:125], v97 offset:18432
    v_mfma_f32_32x32x16_bf16 v[16:31], a[136:139], v[140:143], v[16:31]
    s_waitcnt vmcnt(11)
    v_max3_u32 v90, v144, v148, v152
    ds_read_b64_tr_b16 a[126:127], v97 offset:19456
    v_mfma_f32_32x32x16_bf16 v[48:63], a[140:143], v[140:143], v[48:63]
    buffer_load_dwordx4 v[136:139], v123, s[12:15], s30 offen offset:0 sc1
    s_waitcnt vmcnt(11)
    v_max3_u32 v90, v90, v156, v156
    v_cmp_eq_u32 vcc, -1, v90
    s_cbranch_vccnz G3S9
G3R9:
    v_mfma_f32_32x32x16_bf16 v[0:15], a[144:147], v[144:147], v[0:15]
    v_mfma_f32_32x32x16_bf16 v[32:47], a[148:151], v[144:147], v[32:47]
    buffer_load_dwordx4 v[140:143], v123, s[12:15], s30 offen offset:512 sc1
    v_mfma_f32_32x32x16_bf16 v[16:31], a[144:147], v[148:151], v[16:31]
    v_mfma_f32_32x32x16_bf16 v[48:63], a[148:151], v[148:151], v[48:63]
    buffer_load_dwordx4 v[144:147], v123, s[12:15], s31 offen offset:0 sc1
    v_mfma_f32_32x32x16_bf16 v[0:15], a[152:155], v[152:155], v[0:15]
    v_mfma_f32_32x32x16_bf16 v[32:47], a[156:159], v[152:155], v[32:47]
    buffer_load_dwordx4 v[148:151], v123, s[12:15], s31 offen offset:512 sc1
    v_mfma_f32_32x32x16_bf16 v[16:31], a[152:155], v[156:159], v[16:31]
    s_waitcnt vmcnt(11)
    v_max3_u32 v90, v160, v164, v168
    v_mfma_f32_32x32x16_bf16 v[48:63], a[156:159], v[156:159], v[48:63]
    buffer_load_dwordx4 v[152:155], v123, s[12:15], s32 offen offset:0 sc1
    s_waitcnt vmcnt(11)
    v_max3_u32 v90, v90, v172, v172
    v_cmp_eq_u32 vcc, -1, v90
    s_cbranch_vccnz G3S10
G3R10:
    v_mfma_f32_32x32x16_bf16 v[0:15], a[160:163], v[160:163], v[0:15]
    v_mfma_f32_32x32x16_bf16 v[32:47], a[164:167], v[160:163], v[32:47]
    buffer_load_dwordx4 v[156:159], v123, s[12:15], s32 offen offset:512 sc1
    v_mfma_f32_32x32x16_bf16 v[16:31], a[160:163], v[164:167], v[16:31]
    v_mfma_f32_32x32x16_bf16 v[48:63], a[164:167], v[164:167], v[48:63]
    buffer_load_dwordx4 v[160:163], v122, s[12:15], s29 offen offset:0 sc1
    v_mfma_f32_32x32x16_bf16 v[0:15], a[168:171], v[168:171], v[0:15]
    v_mfma_f32_32x32x16_bf16 v[32:47], a[172:175], v[168:171], v[32:47]
    buffer_load_dwordx4 v[164:167], v122, s[12:15], s29 offen offset:512 sc1
    v_mfma_f32_32x32x16_bf16 v[16:31], a[168:171], v[172:175], v[16:31]
    s_waitcnt vmcnt(11)
    v_max3_u32 v90, v176, v180, v184
    v_mfma_f32_32x32x16_bf16 v[48:63], a[172:175], v[172:175], v[48:63]
    buffer_load_dwordx4 v[168:171], v122, s[12:15], s30 offen offset:0 sc1
    s_waitcnt vmcnt(11)
    v_max3_u32 v90, v90, v188, v188
    v_cmp_eq_u32 vcc, -1, v90
    s_cbranch_vccnz G3S11
G3R11:
    v_mfma_f32_32x32x16_bf16 v[0:15], a[176:179], v[176:179], v[0:15]
    v_mfma_f32_32x32x16_bf16 v[32:47], a[180:183], v[176:179], v[32:47]
    buffer_load_dwordx4 v[172:175], v122, s[12:15], s30 offen offset:512 sc1
    v_mfma_f32_32x32x16_bf16 v[16:31], a[176:179], v[180:183], v[16:31]
    v_mfma_f32_32x32x16_bf16 v[48:63], a[180:183], v[180:183], v[48:63]
    buffer_load_dwordx4 v[176:179], v122, s[12:15], s31 offen offset:0 sc1
    v_mfma_f32_32x32x16_bf16 v[0:15], a[184:187], v[184:187], v[0:15]
    v_mfma_f32_32x32x16_bf16 v[32:47], a[188:191], v[184:187], v[32:47]
    buffer_load_dwordx4 v[180:183], v122, s[12:15], s31 offen offset:512 sc1
    v_mfma_f32_32x32x16_bf16 v[16:31], a[184:187], v[188:191], v[16:31]
    s_waitcnt vmcnt(11)
    v_max3_u32 v90, v128, v132, v136
    v_mfma_f32_32x32x16_bf16 v[48:63], a[188:191], v[188:191], v[48:63]
    buffer_load_dwordx4 v[184:187], v122, s[12:15], s32 offen offset:0 sc1
    s_waitcnt vmcnt(11)
    v_max3_u32 v90, v90, v140, v140
    v_cmp_eq_u32 vcc, -1, v90
    s_cbranch_vccnz G3S12
G3R12:
    v_mfma_f32_32x32x16_bf16 v[16:31], a[192:195], v[128:131], v[16:31]
    v_mfma_f32_32x32x16_bf16 v[48:63], a[196:199], v[128:131], v[48:63]
    buffer_load_dwordx4 v[188:191], v122, s[12:15], s32 offen offset:512 sc1
    v_mfma_f32_32x32x16_bf16 v[16:31], a[200:203], v[132:135], v[16:31]
    v_mfma_f32_32x32x16_bf16 v[48:63], a[204:207], v[132:135], v[48:63]
    v_mfma_f32_32x32x16_bf16 v[16:31], a[208:211], v[136:139], v[16:31]
    v_mfma_f32_32x32x16_bf16 v[48:63], a[212:215], v[136:139], v[48:63]
    v_mfma_f32_32x32x16_bf16 v[16:31], a[216:219], v[140:143], v[16:31]
    s_waitcnt vmcnt(9)
    v_max3_u32 v90, v144, v148, v152
    v_mfma_f32_32x32x16_bf16 v[48:63], a[220:223], v[140:143], v[48:63]
    s_waitcnt vmcnt(8)
    v_max3_u32 v90, v90, v156, v156
    v_cmp_eq_u32 vcc, -1, v90
    s_cbranch_vccnz G3S13
G3R13:
    v_mfma_f32_32x32x16_bf16 v[16:31], a[224:227], v[144:147], v[16:31]
    v_mfma_f32_32x32x16_bf16 v[48:63], a[228:231], v[144:147], v[48:63]
    v_mfma_f32_32x32x16_bf16 v[16:31], a[232:235], v[148:151], v[16:31]
    v_mfma_f32_32x32x16_bf16 v[48:63], a[236:239], v[148:151], v[48:63]
    v_mfma_f32_32x32x16_bf16 v[16:31], a[240:243], v[152:155], v[16:31]
    v_mfma_f32_32x32x16_bf16 v[48:63], a[244:247], v[152:155], v[48:63]
    v_mfma_f32_32x32x16_bf16 v[16:31], a[248:251], v[156:159], v[16:31]
    s_waitcnt vmcnt(5)
    v_max3_u32 v90, v160, v164, v168
    v_mfma_f32_32x32x16_bf16 v[48:63], a[252:255], v[156:159], v[48:63]
    s_waitcnt vmcnt(4)
    v_max3_u32 v90, v90, v172, v172
    v_cmp_eq_u32 vcc, -1, v90
    s_cbranch_vccnz G3S14
G3R14:
    v_mfma_f32_32x32x16_bf16 v[0:15], a[192:195], v[160:163], v[0:15]
    s_waitcnt lgkmcnt(0)
    s_barrier
    v_mfma_f32_32x32x16_bf16 v[32:47], a[196:199], v[160:163], v[32:47]
    v_mfma_f32_32x32x16_bf16 v[0:15], a[200:203], v[164:167], v[0:15]
    ds_write_b128 v114, v[16:19] offset:0
    v_mfma_f32_32x32x16_bf16 v[32:47], a[204:207], v[164:167], v[32:47]
    ds_write_b128 v114, v[20:23] offset:1024
    v_mfma_f32_32x32x16_bf16 v[0:15], a[208:211], v[168:171], v[0:15]
    ds_write_b128 v114, v[24:27] offset:2048
    v_mfma_f32_32x32x16_bf16 v[32:47], a[212:215], v[168:171], v[32:47]
    ds_write_b128 v114, v[28:31] offset:3072
    v_mfma_f32_32x32x16_bf16 v[0:15], a[216:219], v[172:175], v[0:15]
    s_waitcnt vmcnt(1)
    v_max3_u32 v90, v176, v180, v184
    ds_write_b128 v116, v[48:51] offset:0
    v_mfma_f32_32x32x16_bf16 v[32:47], a[220:223], v[172:175], v[32:47]
    s_waitcnt vmcnt(0)
    v_max3_u32 v90, v90, v188, v188
    ds_write_b128 v116, v[52:55] offset:1024
    v_cmp_eq_u32 vcc, -1, v90
    s_cbranch_vccnz G3S15
G3R15:
    v_mfma_f32_32x32x16_bf16 v[0:15], a[224:227], v[176:179], v[0:15]
    ds_write_b128 v116, v[56:59] offset:2048
    v_mfma_f32_32x32x16_bf16 v[32:47], a[228:231], v[176:179], v[32:47]
    ds_write_b128 v116, v[60:63] offset:3072
    v_mfma_f32_32x32x16_bf16 v[0:15], a[232:235], v[180:183], v[0:15]
    v_mfma_f32_32x32x16_bf16 v[32:47], a[236:239], v[180:183], v[32:47]
    v_mfma_f32_32x32x16_bf16 v[0:15], a[240:243], v[184:187], v[0:15]
    v_mfma_f32_32x32x16_bf16 v[32:47], a[244:247], v[184:187], v[32:47]
    v_mfma_f32_32x32x16_bf16 v[0:15], a[248:251], v[188:191], v[0:15]
    v_mfma_f32_32x32x16_bf16 v[32:47], a[252:255], v[188:191], v[32:47]
    s_lshl_b32 s3, s74, 1
    s_add_u32 s80, s3, s16
    s_lshl_b32 s3, s72, 1
    s_add_u32 s81, s3, s17
    s_lshl_b32 s3, s81, 7
    s_add_u32 s3, s3, s80
    s_lshl_b32 s3, s3, 10
    s_add_u32 s3, s3, 5242880
    s_mov_b32 s9, s3
    v_mov_b32 v206, v119
    buffer_load_dwordx4 v[192:195], v206, s[12:15], s9 offen offset:0 sc1
    buffer_load_dwordx4 v[196:199], v206, s[12:15], s9 offen offset:512 sc1
    v_lshlrev_b32 v205, 4, v245
    s_lshl_b32 s8, s80, 9
    s_add_u32 s8, s8, 9437184
    buffer_load_dwordx4 v[200:203], v205, s[12:15], s8 offen sc1
    v_lshlrev_b32 v243, 1, v245
    s_lshl_b32 s3, s80, 6
    buffer_load_ushort v204, v243, s[56:59], s3 offen
    s_add_u32 s21, s87, 3801088
    s_add_u32 m0, s69, 24576
    s_nop 0
    buffer_load_dwordx4 v92, s[44:47], s21 offen offset:0 lds
    ds_write_b128 v115, v[32:35] offset:0
    ds_write_b128 v115, v[36:39] offset:1024
    ds_write_b128 v115, v[40:43] offset:2048
    ds_write_b128 v115, v[44:47] offset:3072
    buffer_load_dwordx4 v93, s[44:47], s21 offen offset:1024 lds
    buffer_load_dwordx4 v94, s[44:47], s21 offen offset:2048 lds
    s_waitcnt lgkmcnt(0)
    s_barrier
    ds_read_b128 v[16:19], v253 offset:0
    ds_read_b128 v[20:23], v253 offset:1024
    ds_read_b128 v[24:27], v253 offset:2048
    ds_read_b128 v[28:31], v253 offset:3072
    buffer_load_dwordx4 v95, s[44:47], s21 offen offset:3072 lds
    ds_read_b128 v[32:35], v253 offset:4096
    ds_read_b128 v[36:39], v253 offset:5120
    ds_read_b128 v[40:43], v253 offset:6144
    ds_read_b128 v[44:47], v253 offset:7168
    s_add_u32 s21, s87, 3932160
    s_add_u32 m0, s69, 28672
    s_nop 0
    buffer_load_dwordx4 v92, s[44:47], s21 offen offset:0 lds
    ds_read_b128 v[48:51], v253 offset:8192
    ds_read_b128 v[52:55], v253 offset:9216
    ds_read_b128 v[56:59], v253 offset:10240
    ds_read_b128 v[60:63], v253 offset:11264
    buffer_load_dwordx4 v93, s[44:47], s21 offen offset:1024 lds
    s_waitcnt lgkmcnt(11)
    v_pk_add_f32 v[0:1], v[0:1], v[16:17]
    v_pk_add_f32 v[2:3], v[2:3], v[18:19]
    s_waitcnt lgkmcnt(10)
    v_pk_add_f32 v[4:5], v[4:5], v[20:21]
    v_pk_add_f32 v[6:7], v[6:7], v[22:23]
    s_waitcnt lgkmcnt(9)
    v_pk_add_f32 v[8:9], v[8:9], v[24:25]
    v_pk_add_f32 v[10:11], v[10:11], v[26:27]
    s_waitcnt lgkmcnt(8)
    v_pk_add_f32 v[12:13], v[12:13], v[28:29]
    v_pk_add_f32 v[14:15], v[14:15], v[30:31]
    s_waitcnt lgkmcnt(7)
    v_pk_add_f32 v[0:1], v[0:1], v[32:33]
    v_pk_add_f32 v[2:3], v[2:3], v[34:35]
    s_waitcnt lgkmcnt(6)
    v_pk_add_f32 v[4:5], v[4:5], v[36:37]
    v_pk_add_f32 v[6:7], v[6:7], v[38:39]
    s_waitcnt lgkmcnt(5)
    v_pk_add_f32 v[8:9], v[8:9], v[40:41]
    v_pk_add_f32 v[10:11], v[10:11], v[42:43]
    s_waitcnt lgkmcnt(4)
    v_pk_add_f32 v[12:13], v[12:13], v[44:45]
    v_pk_add_f32 v[14:15], v[14:15], v[46:47]
    s_waitcnt lgkmcnt(3)
    v_pk_add_f32 v[0:1], v[0:1], v[48:49]
    v_pk_add_f32 v[2:3], v[2:3], v[50:51]
    s_waitcnt lgkmcnt(2)
    v_pk_add_f32 v[4:5], v[4:5], v[52:53]
    v_pk_add_f32 v[6:7], v[6:7], v[54:55]
    s_waitcnt lgkmcnt(1)
    v_pk_add_f32 v[8:9], v[8:9], v[56:57]
    v_pk_add_f32 v[10:11], v[10:11], v[58:59]
    s_waitcnt lgkmcnt(0)
    v_pk_add_f32 v[12:13], v[12:13], v[60:61]
    v_pk_add_f32 v[14:15], v[14:15], v[62:63]
    s_mov_b32 s10, 0xbdd2d3e8
    s_mov_b32 s11, 0xbdd2d3e8
    v_mov_b32 v32, 0xc0135761
    v_mov_b32 v34, 1.0
    v_mov_b32 v243, 57344
    v_mad_u32_u24 v119, v249, v243, v255
    v_pk_mul_f32 v[16:17], v[0:1], v[0:1]
    v_pk_mul_f32 v[18:19], v[2:3], v[2:3]
    v_pk_mul_f32 v[20:21], v[4:5], v[4:5]
    v_pk_mul_f32 v[22:23], v[6:7], v[6:7]
    v_pk_mul_f32 v[24:25], v[8:9], v[8:9]
    v_pk_mul_f32 v[26:27], v[10:11], v[10:11]
    v_pk_mul_f32 v[28:29], v[12:13], v[12:13]
    v_pk_mul_f32 v[30:31], v[14:15], v[14:15]
    buffer_load_dwordx4 v94, s[44:47], s21 offen offset:2048 lds
    buffer_load_dwordx4 v95, s[44:47], s21 offen offset:3072 lds
    v_pk_fma_f32 v[16:17], v[16:17], s[10:11], v[32:33] op_sel_hi:[1,1,0]
    v_pk_fma_f32 v[18:19], v[18:19], s[10:11], v[32:33] op_sel_hi:[1,1,0]
    v_pk_fma_f32 v[20:21], v[20:21], s[10:11], v[32:33] op_sel_hi:[1,1,0]
    v_pk_fma_f32 v[22:23], v[22:23], s[10:11], v[32:33] op_sel_hi:[1,1,0]
    v_pk_fma_f32 v[24:25], v[24:25], s[10:11], v[32:33] op_sel_hi:[1,1,0]
    v_pk_fma_f32 v[26:27], v[26:27], s[10:11], v[32:33] op_sel_hi:[1,1,0]
    v_pk_fma_f32 v[28:29], v[28:29], s[10:11], v[32:33] op_sel_hi:[1,1,0]
    v_pk_fma_f32 v[30:31], v[30:31], s[10:11], v[32:33] op_sel_hi:[1,1,0]
    v_pk_mul_f32 v[16:17], v[16:17], v[0:1]
    v_pk_mul_f32 v[18:19], v[18:19], v[2:3]
    v_pk_mul_f32 v[20:21], v[20:21], v[4:5]
    v_pk_mul_f32 v[22:23], v[22:23], v[6:7]
    v_pk_mul_f32 v[24:25], v[24:25], v[8:9]
    v_pk_mul_f32 v[26:27], v[26:27], v[10:11]
    v_pk_mul_f32 v[28:29], v[28:29], v[12:13]
    v_pk_mul_f32 v[30:31], v[30:31], v[14:15]
    s_add_u32 s21, s87, 4063232
    s_add_u32 m0, s69, 20480
    s_nop 0
    buffer_load_dwordx4 v92, s[44:47], s21 offen offset:0 lds
    buffer_load_dwordx4 v93, s[44:47], s21 offen offset:1024 lds
    v_exp_f32 v16, v16
    v_exp_f32 v17, v17
    v_exp_f32 v18, v18
    v_exp_f32 v19, v19
    v_exp_f32 v20, v20
    v_exp_f32 v21, v21
    v_exp_f32 v22, v22
    v_exp_f32 v23, v23
    v_exp_f32 v24, v24
    v_exp_f32 v25, v25
    v_exp_f32 v26, v26
    v_exp_f32 v27, v27
    v_exp_f32 v28, v28
    v_exp_f32 v29, v29
    v_exp_f32 v30, v30
    v_exp_f32 v31, v31
    buffer_load_dwordx4 v94, s[44:47], s21 offen offset:2048 lds
    buffer_load_dwordx4 v95, s[44:47], s21 offen offset:3072 lds
    v_pk_add_f32 v[16:17], v[16:17], v[34:35] op_sel_hi:[1,0]
    v_pk_add_f32 v[18:19], v[18:19], v[34:35] op_sel_hi:[1,0]
    v_pk_add_f32 v[20:21], v[20:21], v[34:35] op_sel_hi:[1,0]
    v_pk_add_f32 v[22:23], v[22:23], v[34:35] op_sel_hi:[1,0]
    v_pk_add_f32 v[24:25], v[24:25], v[34:35] op_sel_hi:[1,0]
    v_pk_add_f32 v[26:27], v[26:27], v[34:35] op_sel_hi:[1,0]
    v_pk_add_f32 v[28:29], v[28:29], v[34:35] op_sel_hi:[1,0]
    v_pk_add_f32 v[30:31], v[30:31], v[34:35] op_sel_hi:[1,0]
    v_rcp_f32 v16, v16
    v_rcp_f32 v17, v17
    v_rcp_f32 v18, v18
    v_rcp_f32 v19, v19
    v_rcp_f32 v20, v20
    v_rcp_f32 v21, v21
    v_rcp_f32 v22, v22
    v_rcp_f32 v23, v23
    v_rcp_f32 v24, v24
    v_rcp_f32 v25, v25
    v_rcp_f32 v26, v26
    v_rcp_f32 v27, v27
    v_rcp_f32 v28, v28
    v_rcp_f32 v29, v29
    v_rcp_f32 v30, v30
    v_rcp_f32 v31, v31
    v_pk_mul_f32 v[0:1], v[0:1], v[16:17]
    v_pk_mul_f32 v[2:3], v[2:3], v[18:19]
    v_pk_mul_f32 v[4:5], v[4:5], v[20:21]
    v_pk_mul_f32 v[6:7], v[6:7], v[22:23]
    v_pk_mul_f32 v[8:9], v[8:9], v[24:25]
    v_pk_mul_f32 v[10:11], v[10:11], v[26:27]
    v_pk_mul_f32 v[12:13], v[12:13], v[28:29]
    v_pk_mul_f32 v[14:15], v[14:15], v[30:31]
    v_cvt_pk_bf16_f32 v32, v0, v1
    v_cvt_pk_bf16_f32 v33, v2, v3
    v_cvt_pk_bf16_f32 v34, v4, v5
    v_cvt_pk_bf16_f32 v35, v6, v7
    v_cvt_pk_bf16_f32 v36, v8, v9
    v_cvt_pk_bf16_f32 v37, v10, v11
    v_cvt_pk_bf16_f32 v38, v12, v13
    v_cvt_pk_bf16_f32 v39, v14, v15
    buffer_store_dwordx4 v[32:35], v119, s[12:15], s19 offen sc1
    buffer_store_dwordx4 v[36:39], v119, s[12:15], s19 offen offset:512 sc1
    s_add_u32 s21, s87, 4194304
    s_add_u32 m0, s69, 32768
    s_nop 0
    buffer_load_dwordx4 v92, s[44:47], s21 offen offset:0 lds
    buffer_load_dwordx4 v93, s[44:47], s21 offen offset:1024 lds
    buffer_load_dwordx4 v94, s[44:47], s21 offen offset:2048 lds
    buffer_load_dwordx4 v95, s[44:47], s21 offen offset:3072 lds
    s_add_u32 s21, s87, 4325376
    s_add_u32 m0, s69, 36864
    s_nop 0
    buffer_load_dwordx4 v92, s[44:47], s21 offen offset:0 lds
    buffer_load_dwordx4 v93, s[44:47], s21 offen offset:1024 lds
    buffer_load_dwordx4 v94, s[44:47], s21 offen offset:2048 lds
    buffer_load_dwordx4 v95, s[44:47], s21 offen offset:3072 lds
    s_add_u32 s21, s87, 4456448
    s_add_u32 m0, s69, 12288
    s_nop 0
    buffer_load_dwordx4 v92, s[44:47], s21 offen offset:0 lds
    buffer_load_dwordx4 v93, s[44:47], s21 offen offset:1024 lds
    buffer_load_dwordx4 v94, s[44:47], s21 offen offset:2048 lds
    buffer_load_dwordx4 v95, s[44:47], s21 offen offset:3072 lds
    v_mov_b32 v243, 57344
    v_mad_u32_u24 v244, v249, v243, v255
    s_mul_i32 s3, s17, 114688
    v_add_u32 v112, s3, v244
    s_xor_b32 s3, s17, 1
    s_mul_i32 s3, s3, 114688
    v_add_u32 v113, s3, v244
    s_mul_i32 s78, s72, 229376
    s_mul_i32 s79, s66, 7168
    s_add_u32 s78, s78, s79
    s_add_u32 s25, s78, 7077888
    s_add_u32 s26, s78, 7081984
    s_add_u32 s27, s78, 7106560
    s_add_u32 s28, s78, 7110656
    v_mul_u32_u24 v117, 896, v245
    v_lshl_add_u32 v117, v246, 4, v117
    s_mul_i32 s19, s80, 28672
    s_lshl_b32 s78, s81, 6
    s_add_u32 s19, s19, s78
    s_barrier
    s_sleep 11
    s_mov_b32 s84, 40000
    buffer_load_dwordx4 v[128:131], v112, s[12:15], s25 offen offset:0 sc1
    buffer_load_dwordx4 v[132:135], v113, s[12:15], s25 offen offset:0 sc1
    buffer_load_dwordx4 v[136:139], v112, s[12:15], s25 offen offset:512 sc1
    buffer_load_dwordx4 v[140:143], v113, s[12:15], s25 offen offset:512 sc1
    buffer_load_dwordx4 v[144:147], v112, s[12:15], s25 offen offset:1024 sc1
    buffer_load_dwordx4 v[148:151], v113, s[12:15], s25 offen offset:1024 sc1
    buffer_load_dwordx4 v[152:155], v112, s[12:15], s25 offen offset:1536 sc1
    buffer_load_dwordx4 v[156:159], v113, s[12:15], s25 offen offset:1536 sc1
    buffer_load_dwordx4 v[160:163], v112, s[12:15], s25 offen offset:2048 sc1
    buffer_load_dwordx4 v[164:167], v113, s[12:15], s25 offen offset:2048 sc1
    buffer_load_dwordx4 v[168:171], v112, s[12:15], s25 offen offset:2560 sc1
    buffer_load_dwordx4 v[172:175], v113, s[12:15], s25 offen offset:2560 sc1
    s_waitcnt vmcnt(34)
    ds_read_b64_tr_b16 a[128:129], v96 offset:24576
    ds_read_b64_tr_b16 a[130:131], v96 offset:25600
    ds_read_b64_tr_b16 a[132:133], v97 offset:24576
    ds_read_b64_tr_b16 a[134:135], v97 offset:25600
    ds_read_b64_tr_b16 a[136:137], v96 offset:26624
    ds_read_b64_tr_b16 a[138:139], v96 offset:27648
    ds_read_b64_tr_b16 a[140:141], v97 offset:26624
    ds_read_b64_tr_b16 a[142:143], v97 offset:27648
    s_waitcnt vmcnt(30)
    ds_read_b64_tr_b16 a[144:145], v96 offset:28672
    ds_read_b64_tr_b16 a[146:147], v96 offset:29696
    ds_read_b64_tr_b16 a[148:149], v97 offset:28672
    ds_read_b64_tr_b16 a[150:151], v97 offset:29696
    ds_read_b64_tr_b16 a[152:153], v96 offset:30720
    ds_read_b64_tr_b16 a[154:155], v96 offset:31744
    ds_read_b64_tr_b16 a[156:157], v97 offset:30720
    ds_read_b64_tr_b16 a[158:159], v97 offset:31744
    s_waitcnt vmcnt(26)
    ds_read_b64_tr_b16 a[160:161], v96 offset:20480
    ds_read_b64_tr_b16 a[162:163], v96 offset:21504
    ds_read_b64_tr_b16 a[164:165], v97 offset:20480
    ds_read_b64_tr_b16 a[166:167], v97 offset:21504
    ds_read_b64_tr_b16 a[168:169], v96 offset:22528
    ds_read_b64_tr_b16 a[170:171], v96 offset:23552
    ds_read_b64_tr_b16 a[172:173], v97 offset:22528
    ds_read_b64_tr_b16 a[174:175], v97 offset:23552
    s_waitcnt vmcnt(20)
    ds_read_b64_tr_b16 a[176:177], v96 offset:32768
    ds_read_b64_tr_b16 a[178:179], v96 offset:33792
    ds_read_b64_tr_b16 a[180:181], v97 offset:32768
    ds_read_b64_tr_b16 a[182:183], v97 offset:33792
    ds_read_b64_tr_b16 a[184:185], v96 offset:34816
    ds_read_b64_tr_b16 a[186:187], v96 offset:35840
    ds_read_b64_tr_b16 a[188:189], v97 offset:34816
    ds_read_b64_tr_b16 a[190:191], v97 offset:35840
    s_waitcnt vmcnt(16)
    ds_read_b64_tr_b16 a[192:193], v96 offset:36864
    ds_read_b64_tr_b16 a[194:195], v96 offset:37888
    ds_read_b64_tr_b16 a[196:197], v97 offset:36864
    ds_read_b64_tr_b16 a[198:199], v97 offset:37888
    ds_read_b64_tr_b16 a[200:201], v96 offset:38912
    ds_read_b64_tr_b16 a[202:203], v96 offset:39936
    ds_read_b64_tr_b16 a[204:205], v97 offset:38912
    ds_read_b64_tr_b16 a[206:207], v97 offset:39936
    s_waitcnt vmcnt(12)
    ds_read_b64_tr_b16 a[208:209], v96 offset:12288
    ds_read_b64_tr_b16 a[210:211], v96 offset:13312
    ds_read_b64_tr_b16 a[212:213], v97 offset:12288
    ds_read_b64_tr_b16 a[214:215], v97 offset:13312
    ds_read_b64_tr_b16 a[216:217], v96 offset:14336
    ds_read_b64_tr_b16 a[218:219], v96 offset:15360
    ds_read_b64_tr_b16 a[220:221], v97 offset:14336
    ds_read_b64_tr_b16 a[222:223], v97 offset:15360
    s_mov_b32 s84, 40000
    v_xor_b32 v242, s67, v202
    v_bitop3_b32 v242, s68, v203, v242 bitop3:0xbe
    v_cmp_ne_u32 s[62:63], 0, v242
    v_max3_u32 v90, v192, v196, v196
    v_cmp_eq_u32 vcc, -1, v90
    s_nop 1
    s_or_b64 vcc, vcc, s[62:63]
    s_cbranch_vccnz FSS
FSR:
    v_lshlrev_b32 v204, 16, v204
    v_add_f32 v204, v204, v200
    v_cvt_pk_bf16_f32 v202, v201, v201
    v_and_b32 v242, 0xffff0000, v202
    v_sub_f32 v242, v201, v242
    v_cvt_pk_bf16_f32 v203, v242, v242
    v_mov_b32 v0, v204
    v_mov_b32 v1, v204
    v_mov_b32 v2, v204
    v_mov_b32 v3, v204
    v_mov_b32 v4, v204
    v_mov_b32 v5, v204
    v_mov_b32 v6, v204
    v_mov_b32 v7, v204
    v_mov_b32 v8, v204
    v_mov_b32 v9, v204
    v_mov_b32 v10, v204
    v_mov_b32 v11, v204
    v_mov_b32 v12, v204
    v_mov_b32 v13, v204
    v_mov_b32 v14, v204
    v_mov_b32 v15, v204
    v_lshlrev_b32 v242, 3, v246
    v_sub_u32 v242, v245, v242
    v_and_b32 v243, 1, v242
    v_cmp_eq_u32 vcc, 1, v243
    v_mov_b32 v243, 0xffff
    v_mov_b32 v244, 0xffff0000
    v_cndmask_b32 v243, v243, v244, vcc
    v_and_b32 v202, v202, v243
    v_and_b32 v203, v203, v243
    v_ashrrev_i32 v242, 1, v242
    v_cmp_eq_u32 vcc, 0, v242
    s_nop 1
    v_cndmask_b32 v208, 0, v202, vcc
    v_cndmask_b32 v216, 0, v203, vcc
    v_cmp_eq_u32 vcc, 1, v242
    s_nop 1
    v_cndmask_b32 v209, 0, v202, vcc
    v_cndmask_b32 v217, 0, v203, vcc
    v_cmp_eq_u32 vcc, 2, v242
    s_nop 1
    v_cndmask_b32 v210, 0, v202, vcc
    v_cndmask_b32 v218, 0, v203, vcc
    v_cmp_eq_u32 vcc, 3, v242
    s_nop 1
    v_cndmask_b32 v211, 0, v202, vcc
    v_cndmask_b32 v219, 0, v203, vcc
    v_cmp_eq_u32 vcc, 8, v242
    s_nop 1
    v_cndmask_b32 v212, 0, v202, vcc
    v_cndmask_b32 v220, 0, v203, vcc
    v_cmp_eq_u32 vcc, 9, v242
    s_nop 1
    v_cndmask_b32 v213, 0, v202, vcc
    v_cndmask_b32 v221, 0, v203, vcc
    v_cmp_eq_u32 vcc, 10, v242
    s_nop 1
    v_cndmask_b32 v214, 0, v202, vcc
    v_cndmask_b32 v222, 0, v203, vcc
    v_cmp_eq_u32 vcc, 11, v242
    s_nop 1
    v_cndmask_b32 v215, 0, v202, vcc
    v_cndmask_b32 v223, 0, v203, vcc
    v_mfma_f32_32x32x16_bf16 v[0:15], v[192:195], v[208:211], v[0:15]
    v_mfma_f32_32x32x16_bf16 v[0:15], v[196:199], v[212:215], v[0:15]
    v_mfma_f32_32x32x16_bf16 v[0:15], v[192:195], v[216:219], v[0:15]
    v_mfma_f32_32x32x16_bf16 v[0:15], v[196:199], v[220:223], v[0:15]
    s_mov_b32 s84, 40000
    s_waitcnt lgkmcnt(0)
    s_waitcnt vmcnt(9)
    v_max3_u32 v90, v128, v132, v136
    s_waitcnt vmcnt(8)
    v_max3_u32 v90, v90, v140, v140
    v_cmp_eq_u32 vcc, -1, v90
    s_cbranch_vccnz G4S0
G4R0:
    v_mfma_f32_32x32x16_bf16 v[0:15], v[128:131], a[0:3], v[0:15]
    buffer_load_dwordx4 v[176:179], v112, s[12:15], s25 offen offset:3072 sc1
    v_mfma_f32_32x32x16_bf16 v[16:31], v[128:131], a[4:7], 0
    buffer_load_dwordx4 v[180:183], v113, s[12:15], s25 offen offset:3072 sc1
    v_mfma_f32_32x32x16_bf16 v[32:47], v[132:135], a[0:3], 0
    buffer_load_dwordx4 v[184:187], v112, s[12:15], s25 offen offset:3584 sc1
    v_mfma_f32_32x32x16_bf16 v[48:63], v[132:135], a[4:7], 0
    buffer_load_dwordx4 v[188:191], v113, s[12:15], s25 offen offset:3584 sc1
    v_mfma_f32_32x32x16_bf16 v[0:15], v[136:139], a[8:11], v[0:15]
    buffer_load_dwordx4 v[128:131], v112, s[12:15], s26 offen offset:0 sc1
    v_mfma_f32_32x32x16_bf16 v[16:31], v[136:139], a[12:15], v[16:31]
    buffer_load_dwordx4 v[132:135], v113, s[12:15], s26 offen offset:0 sc1
    v_mfma_f32_32x32x16_bf16 v[32:47], v[140:143], a[8:11], v[32:47]
    s_waitcnt vmcnt(11)
    v_max3_u32 v90, v144, v148, v152
    v_mfma_f32_32x32x16_bf16 v[48:63], v[140:143], a[12:15], v[48:63]
    buffer_load_dwordx4 v[136:139], v112, s[12:15], s26 offen offset:512 sc1
    s_waitcnt vmcnt(11)
    v_max3_u32 v90, v90, v156, v156
    v_cmp_eq_u32 vcc, -1, v90
    s_cbranch_vccnz G4S1
G4R1:
    v_mfma_f32_32x32x16_bf16 v[0:15], v[144:147], a[16:19], v[0:15]
    v_mfma_f32_32x32x16_bf16 v[16:31], v[144:147], a[20:23], v[16:31]
    buffer_load_dwordx4 v[140:143], v113, s[12:15], s26 offen offset:512 sc1
    v_mfma_f32_32x32x16_bf16 v[32:47], v[148:151], a[16:19], v[32:47]
    v_mfma_f32_32x32x16_bf16 v[48:63], v[148:151], a[20:23], v[48:63]
    buffer_load_dwordx4 v[144:147], v112, s[12:15], s26 offen offset:1024 sc1
    v_mfma_f32_32x32x16_bf16 v[0:15], v[152:155], a[24:27], v[0:15]
    v_mfma_f32_32x32x16_bf16 v[16:31], v[152:155], a[28:31], v[16:31]
    buffer_load_dwordx4 v[148:151], v113, s[12:15], s26 offen offset:1024 sc1
    v_mfma_f32_32x32x16_bf16 v[32:47], v[156:159], a[24:27], v[32:47]
    s_waitcnt vmcnt(11)
    v_max3_u32 v90, v160, v164, v168
    v_mfma_f32_32x32x16_bf16 v[48:63], v[156:159], a[28:31], v[48:63]
    buffer_load_dwordx4 v[152:155], v112, s[12:15], s26 offen offset:1536 sc1
    s_waitcnt vmcnt(11)
    v_max3_u32 v90, v90, v172, v172
    v_cmp_eq_u32 vcc, -1, v90
    s_cbranch_vccnz G4S2
G4R2:
    v_mfma_f32_32x32x16_bf16 v[0:15], v[160:163], a[32:35], v[0:15]
    v_mfma_f32_32x32x16_bf16 v[16:31], v[160:163], a[36:39], v[16:31]
    buffer_load_dwordx4 v[156:159], v113, s[12:15], s26 offen offset:1536 sc1
    v_mfma_f32_32x32x16_bf16 v[32:47], v[164:167], a[32:35], v[32:47]
    v_mfma_f32_32x32x16_bf16 v[48:63], v[164:167], a[36:39], v[48:63]
    buffer_load_dwordx4 v[160:163], v112, s[12:15], s26 offen offset:2048 sc1
    v_mfma_f32_32x32x16_bf16 v[0:15], v[168:171], a[40:43], v[0:15]
    v_mfma_f32_32x32x16_bf16 v[16:31], v[168:171], a[44:47], v[16:31]
    buffer_load_dwordx4 v[164:167], v113, s[12:15], s26 offen offset:2048 sc1
    v_mfma_f32_32x32x16_bf16 v[32:47], v[172:175], a[40:43], v[32:47]
    s_waitcnt vmcnt(11)
    v_max3_u32 v90, v176, v180, v184
    v_mfma_f32_32x32x16_bf16 v[48:63], v[172:175], a[44:47], v[48:63]
    buffer_load_dwordx4 v[168:171], v112, s[12:15], s26 offen offset:2560 sc1
    s_waitcnt vmcnt(11)
    v_max3_u32 v90, v90, v188, v188
    v_cmp_eq_u32 vcc, -1, v90
    s_cbranch_vccnz G4S3
G4R3:
    v_mfma_f32_32x32x16_bf16 v[0:15], v[176:179], a[48:51], v[0:15]
    v_mfma_f32_32x32x16_bf16 v[16:31], v[176:179], a[52:55], v[16:31]
    buffer_load_dwordx4 v[172:175], v113, s[12:15], s26 offen offset:2560 sc1
    v_mfma_f32_32x32x16_bf16 v[32:47], v[180:183], a[48:51], v[32:47]
    v_mfma_f32_32x32x16_bf16 v[48:63], v[180:183], a[52:55], v[48:63]
    buffer_load_dwordx4 v[176:179], v112, s[12:15], s27 offen offset:0 sc1
    v_mfma_f32_32x32x16_bf16 v[0:15], v[184:187], a[56:59], v[0:15]
    v_mfma_f32_32x32x16_bf16 v[16:31], v[184:187], a[60:63], v[16:31]
    buffer_load_dwordx4 v[180:183], v113, s[12:15], s27 offen offset:0 sc1
    v_mfma_f32_32x32x16_bf16 v[32:47], v[188:191], a[56:59], v[32:47]
    s_waitcnt vmcnt(11)
    v_max3_u32 v90, v128, v132, v136
    v_mfma_f32_32x32x16_bf16 v[48:63], v[188:191], a[60:63], v[48:63]
    buffer_load_dwordx4 v[184:187], v112, s[12:15], s27 offen offset:512 sc1
    s_waitcnt vmcnt(11)
    v_max3_u32 v90, v90, v140, v140
    v_cmp_eq_u32 vcc, -1, v90
    s_cbranch_vccnz G4S4
G4R4:
    v_mfma_f32_32x32x16_bf16 v[0:15], v[128:131], a[64:67], v[0:15]
    v_mfma_f32_32x32x16_bf16 v[16:31], v[128:131], a[68:71], v[16:31]
    buffer_load_dwordx4 v[188:191], v113, s[12:15], s27 offen offset:512 sc1
    v_mfma_f32_32x32x16_bf16 v[32:47], v[132:135], a[64:67], v[32:47]
    v_mfma_f32_32x32x16_bf16 v[48:63], v[132:135], a[68:71], v[48:63]
    buffer_load_dwordx4 v[128:131], v112, s[12:15], s27 offen offset:1024 sc1
    v_mfma_f32_32x32x16_bf16 v[0:15], v[136:139], a[72:75], v[0:15]
    v_mfma_f32_32x32x16_bf16 v[16:31], v[136:139], a[76:79], v[16:31]
    buffer_load_dwordx4 v[132:135], v113, s[12:15], s27 offen offset:1024 sc1
    v_mfma_f32_32x32x16_bf16 v[32:47], v[140:143], a[72:75], v[32:47]
    s_waitcnt vmcnt(11)
    v_max3_u32 v90, v144, v148, v152
    v_mfma_f32_32x32x16_bf16 v[48:63], v[140:143], a[76:79], v[48:63]
    buffer_load_dwordx4 v[136:139], v112, s[12:15], s27 offen offset:1536 sc1
    s_waitcnt vmcnt(11)
    v_max3_u32 v90, v90, v156, v156
    v_cmp_eq_u32 vcc, -1, v90
    s_cbranch_vccnz G4S5
G4R5:
    v_mfma_f32_32x32x16_bf16 v[0:15], v[144:147], a[80:83], v[0:15]
    v_mfma_f32_32x32x16_bf16 v[16:31], v[144:147], a[84:87], v[16:31]
    buffer_load_dwordx4 v[140:143], v113, s[12:15], s27 offen offset:1536 sc1
    v_mfma_f32_32x32x16_bf16 v[32:47], v[148:151], a[80:83], v[32:47]
    v_mfma_f32_32x32x16_bf16 v[48:63], v[148:151], a[84:87], v[48:63]
    buffer_load_dwordx4 v[144:147], v112, s[12:15], s27 offen offset:2048 sc1
    v_mfma_f32_32x32x16_bf16 v[0:15], v[152:155], a[88:91], v[0:15]
    v_mfma_f32_32x32x16_bf16 v[16:31], v[152:155], a[92:95], v[16:31]
    buffer_load_dwordx4 v[148:151], v113, s[12:15], s27 offen offset:2048 sc1
    v_mfma_f32_32x32x16_bf16 v[32:47], v[156:159], a[88:91], v[32:47]
    s_waitcnt vmcnt(11)
    v_max3_u32 v90, v160, v164, v168
    v_mfma_f32_32x32x16_bf16 v[48:63], v[156:159], a[92:95], v[48:63]
    buffer_load_dwordx4 v[152:155], v112, s[12:15], s27 offen offset:2560 sc1
    s_waitcnt vmcnt(11)
    v_max3_u32 v90, v90, v172, v172
    v_cmp_eq_u32 vcc, -1, v90
    s_cbranch_vccnz G4S6
G4R6:
    v_mfma_f32_32x32x16_bf16 v[0:15], v[160:163], a[96:99], v[0:15]
    v_mfma_f32_32x32x16_bf16 v[16:31], v[160:163], a[100:103], v[16:31]
    buffer_load_dwordx4 v[156:159], v113, s[12:15], s27 offen offset:2560 sc1
    v_mfma_f32_32x32x16_bf16 v[32:47], v[164:167], a[96:99], v[32:47]
    v_mfma_f32_32x32x16_bf16 v[48:63], v[164:167], a[100:103], v[48:63]
    buffer_load_dwordx4 v[160:163], v113, s[12:15], s27 offen offset:3072 sc1
    v_mfma_f32_32x32x16_bf16 v[0:15], v[168:171], a[104:107], v[0:15]
    v_mfma_f32_32x32x16_bf16 v[16:31], v[168:171], a[108:111], v[16:31]
    buffer_load_dwordx4 v[164:167], v113, s[12:15], s27 offen offset:3584 sc1
    v_mfma_f32_32x32x16_bf16 v[32:47], v[172:175], a[104:107], v[32:47]
    s_waitcnt vmcnt(11)
    v_max3_u32 v90, v176, v180, v184
    v_mfma_f32_32x32x16_bf16 v[48:63], v[172:175], a[108:111], v[48:63]
    buffer_load_dwordx4 v[168:171], v113, s[12:15], s28 offen offset:0 sc1
    s_waitcnt vmcnt(11)
    v_max3_u32 v90, v90, v188, v188
    v_cmp_eq_u32 vcc, -1, v90
    s_cbranch_vccnz G4S7
G4R7:
    v_mfma_f32_32x32x16_bf16 v[0:15], v[176:179], a[112:115], v[0:15]
    v_mfma_f32_32x32x16_bf16 v[16:31], v[176:179], a[116:119], v[16:31]
    buffer_load_dwordx4 v[172:175], v113, s[12:15], s28 offen offset:512 sc1
    v_mfma_f32_32x32x16_bf16 v[32:47], v[180:183], a[112:115], v[32:47]
    v_mfma_f32_32x32x16_bf16 v[48:63], v[180:183], a[116:119], v[48:63]
    buffer_load_dwordx4 v[176:179], v113, s[12:15], s28 offen offset:1024 sc1
    v_mfma_f32_32x32x16_bf16 v[0:15], v[184:187], a[120:123], v[0:15]
    v_mfma_f32_32x32x16_bf16 v[16:31], v[184:187], a[124:127], v[16:31]
    buffer_load_dwordx4 v[180:183], v113, s[12:15], s28 offen offset:1536 sc1
    v_mfma_f32_32x32x16_bf16 v[32:47], v[188:191], a[120:123], v[32:47]
    s_waitcnt vmcnt(11)
    v_max3_u32 v90, v128, v132, v136
    v_mfma_f32_32x32x16_bf16 v[48:63], v[188:191], a[124:127], v[48:63]
    buffer_load_dwordx4 v[184:187], v113, s[12:15], s28 offen offset:2048 sc1
    s_waitcnt vmcnt(11)
    v_max3_u32 v90, v90, v140, v140
    v_cmp_eq_u32 vcc, -1, v90
    s_cbranch_vccnz G4S8
G4R8:
    v_mfma_f32_32x32x16_bf16 v[0:15], v[128:131], a[128:131], v[0:15]
    v_mfma_f32_32x32x16_bf16 v[16:31], v[128:131], a[132:135], v[16:31]
    buffer_load_dwordx4 v[188:191], v113, s[12:15], s28 offen offset:2560 sc1
    v_mfma_f32_32x32x16_bf16 v[32:47], v[132:135], a[128:131], v[32:47]
    v_mfma_f32_32x32x16_bf16 v[48:63], v[132:135], a[132:135], v[48:63]
    buffer_load_dwordx4 v[128:131], v112, s[12:15], s27 offen offset:3072 sc1
    v_mfma_f32_32x32x16_bf16 v[0:15], v[136:139], a[136:139], v[0:15]
    v_mfma_f32_32x32x16_bf16 v[16:31], v[136:139], a[140:143], v[16:31]
    buffer_load_dwordx4 v[132:135], v112, s[12:15], s27 offen offset:3584 sc1
    v_mfma_f32_32x32x16_bf16 v[32:47], v[140:143], a[136:139], v[32:47]
    s_waitcnt vmcnt(11)
    v_max3_u32 v90, v144, v148, v152
    v_mfma_f32_32x32x16_bf16 v[48:63], v[140:143], a[140:143], v[48:63]
    buffer_load_dwordx4 v[136:139], v112, s[12:15], s28 offen offset:0 sc1
    s_waitcnt vmcnt(11)
    v_max3_u32 v90, v90, v156, v156
    v_cmp_eq_u32 vcc, -1, v90
    s_cbranch_vccnz G4S9
G4R9:
    v_mfma_f32_32x32x16_bf16 v[0:15], v[144:147], a[144:147], v[0:15]
    v_mfma_f32_32x32x16_bf16 v[16:31], v[144:147], a[148:151], v[16:31]
    buffer_load_dwordx4 v[140:143], v112, s[12:15], s28 offen offset:512 sc1
    v_mfma_f32_32x32x16_bf16 v[32:47], v[148:151], a[144:147], v[32:47]
    v_mfma_f32_32x32x16_bf16 v[48:63], v[148:151], a[148:151], v[48:63]
    buffer_load_dwordx4 v[144:147], v112, s[12:15], s28 offen offset:1024 sc1
    v_mfma_f32_32x32x16_bf16 v[0:15], v[152:155], a[152:155], v[0:15]
    v_mfma_f32_32x32x16_bf16 v[16:31], v[152:155], a[156:159], v[16:31]
    buffer_load_dwordx4 v[148:151], v112, s[12:15], s28 offen offset:1536 sc1
    v_mfma_f32_32x32x16_bf16 v[32:47], v[156:159], a[152:155], v[32:47]
    s_waitcnt vmcnt(11)
    v_max3_u32 v90, v160, v164, v168
    v_mfma_f32_32x32x16_bf16 v[48:63], v[156:159], a[156:159], v[48:63]
    buffer_load_dwordx4 v[152:155], v112, s[12:15], s28 offen offset:2048 sc1
    s_waitcnt vmcnt(11)
    v_max3_u32 v90, v90, v172, v172
    v_cmp_eq_u32 vcc, -1, v90
    s_cbranch_vccnz G4S10
G4R10:
    v_mfma_f32_32x32x16_bf16 v[32:47], v[160:163], a[160:163], v[32:47]
    v_mfma_f32_32x32x16_bf16 v[48:63], v[160:163], a[164:167], v[48:63]
    buffer_load_dwordx4 v[156:159], v112, s[12:15], s28 offen offset:2560 sc1
    v_mfma_f32_32x32x16_bf16 v[32:47], v[164:167], a[168:171], v[32:47]
    v_mfma_f32_32x32x16_bf16 v[48:63], v[164:167], a[172:175], v[48:63]
    v_mfma_f32_32x32x16_bf16 v[32:47], v[168:171], a[176:179], v[32:47]
    v_mfma_f32_32x32x16_bf16 v[48:63], v[168:171], a[180:183], v[48:63]
    v_mfma_f32_32x32x16_bf16 v[32:47], v[172:175], a[184:187], v[32:47]
    s_waitcnt vmcnt(9)
    v_max3_u32 v90, v176, v180, v184
    v_mfma_f32_32x32x16_bf16 v[48:63], v[172:175], a[188:191], v[48:63]
    s_waitcnt vmcnt(8)
    v_max3_u32 v90, v90, v188, v188
    v_cmp_eq_u32 vcc, -1, v90
    s_cbranch_vccnz G4S11
G4R11:
    v_mfma_f32_32x32x16_bf16 v[32:47], v[176:179], a[192:195], v[32:47]
    v_mfma_f32_32x32x16_bf16 v[48:63], v[176:179], a[196:199], v[48:63]
    v_mfma_f32_32x32x16_bf16 v[32:47], v[180:183], a[200:203], v[32:47]
    v_mfma_f32_32x32x16_bf16 v[48:63], v[180:183], a[204:207], v[48:63]
    v_mfma_f32_32x32x16_bf16 v[32:47], v[184:187], a[208:211], v[32:47]
    v_mfma_f32_32x32x16_bf16 v[48:63], v[184:187], a[212:215], v[48:63]
    v_mfma_f32_32x32x16_bf16 v[32:47], v[188:191], a[216:219], v[32:47]
    s_waitcnt vmcnt(5)
    v_max3_u32 v90, v128, v132, v136
    v_mfma_f32_32x32x16_bf16 v[48:63], v[188:191], a[220:223], v[48:63]
    s_waitcnt vmcnt(4)
    v_max3_u32 v90, v90, v140, v140
    v_cmp_eq_u32 vcc, -1, v90
    s_cbranch_vccnz G4S12
G4R12:
    v_mfma_f32_32x32x16_bf16 v[0:15], v[128:131], a[160:163], v[0:15]
    v_mfma_f32_32x32x16_bf16 v[16:31], v[128:131], a[164:167], v[16:31]
    v_mfma_f32_32x32x16_bf16 v[0:15], v[132:135], a[168:171], v[0:15]
    s_nop 1
    ds_write_b128 v115, v[32:35] offset:0
    v_mfma_f32_32x32x16_bf16 v[16:31], v[132:135], a[172:175], v[16:31]
    ds_write_b128 v115, v[36:39] offset:1024
    v_mfma_f32_32x32x16_bf16 v[0:15], v[136:139], a[176:179], v[0:15]
    ds_write_b128 v115, v[40:43] offset:2048
    v_mfma_f32_32x32x16_bf16 v[16:31], v[136:139], a[180:183], v[16:31]
    ds_write_b128 v115, v[44:47] offset:3072
    v_mfma_f32_32x32x16_bf16 v[0:15], v[140:143], a[184:187], v[0:15]
    s_waitcnt vmcnt(1)
    v_max3_u32 v90, v144, v148, v152
    ds_write_b128 v116, v[48:51] offset:0
    v_mfma_f32_32x32x16_bf16 v[16:31], v[140:143], a[188:191], v[16:31]
    s_waitcnt vmcnt(0)
    v_max3_u32 v90, v90, v156, v156
    ds_write_b128 v116, v[52:55] offset:1024
    v_cmp_eq_u32 vcc, -1, v90
    s_cbranch_vccnz G4S13
G4R13:
    v_mfma_f32_32x32x16_bf16 v[0:15], v[144:147], a[192:195], v[0:15]
    ds_write_b128 v116, v[56:59] offset:2048
    v_mfma_f32_32x32x16_bf16 v[16:31], v[144:147], a[196:199], v[16:31]
    ds_write_b128 v116, v[60:63] offset:3072
    v_mfma_f32_32x32x16_bf16 v[0:15], v[148:151], a[200:203], v[0:15]
    v_mfma_f32_32x32x16_bf16 v[16:31], v[148:151], a[204:207], v[16:31]
    v_mfma_f32_32x32x16_bf16 v[0:15], v[152:155], a[208:211], v[0:15]
    v_mfma_f32_32x32x16_bf16 v[16:31], v[152:155], a[212:215], v[16:31]
    v_mfma_f32_32x32x16_bf16 v[0:15], v[156:159], a[216:219], v[0:15]
    v_mfma_f32_32x32x16_bf16 v[16:31], v[156:159], a[220:223], v[16:31]
    s_nop 11
    ds_write_b128 v114, v[16:19] offset:0
    ds_write_b128 v114, v[20:23] offset:1024
    ds_write_b128 v114, v[24:27] offset:2048
    ds_write_b128 v114, v[28:31] offset:3072
    s_waitcnt lgkmcnt(0)
    s_barrier
    ds_read_b128 v[16:19], v253 offset:0
    ds_read_b128 v[20:23], v253 offset:1024
    ds_read_b128 v[24:27], v253 offset:2048
    ds_read_b128 v[28:31], v253 offset:3072
    ds_read_b128 v[32:35], v253 offset:4096
    ds_read_b128 v[36:39], v253 offset:5120
    ds_read_b128 v[40:43], v253 offset:6144
    ds_read_b128 v[44:47], v253 offset:7168
    ds_read_b128 v[48:51], v253 offset:8192
    ds_read_b128 v[52:55], v253 offset:9216
    ds_read_b128 v[56:59], v253 offset:10240
    ds_read_b128 v[60:63], v253 offset:11264
    s_waitcnt lgkmcnt(11)
    v_pk_add_f32 v[0:1], v[0:1], v[16:17]
    v_pk_add_f32 v[2:3], v[2:3], v[18:19]
    s_waitcnt lgkmcnt(10)
    v_pk_add_f32 v[4:5], v[4:5], v[20:21]
    v_pk_add_f32 v[6:7], v[6:7], v[22:23]
    s_waitcnt lgkmcnt(9)
    v_pk_add_f32 v[8:9], v[8:9], v[24:25]
    v_pk_add_f32 v[10:11], v[10:11], v[26:27]
    s_waitcnt lgkmcnt(8)
    v_pk_add_f32 v[12:13], v[12:13], v[28:29]
    v_pk_add_f32 v[14:15], v[14:15], v[30:31]
    s_waitcnt lgkmcnt(7)
    v_pk_add_f32 v[0:1], v[0:1], v[32:33]
    v_pk_add_f32 v[2:3], v[2:3], v[34:35]
    s_waitcnt lgkmcnt(6)
    v_pk_add_f32 v[4:5], v[4:5], v[36:37]
    v_pk_add_f32 v[6:7], v[6:7], v[38:39]
    s_waitcnt lgkmcnt(5)
    v_pk_add_f32 v[8:9], v[8:9], v[40:41]
    v_pk_add_f32 v[10:11], v[10:11], v[42:43]
    s_waitcnt lgkmcnt(4)
    v_pk_add_f32 v[12:13], v[12:13], v[44:45]
    v_pk_add_f32 v[14:15], v[14:15], v[46:47]
    s_waitcnt lgkmcnt(3)
    v_pk_add_f32 v[0:1], v[0:1], v[48:49]
    v_pk_add_f32 v[2:3], v[2:3], v[50:51]
    s_waitcnt lgkmcnt(2)
    v_pk_add_f32 v[4:5], v[4:5], v[52:53]
    v_pk_add_f32 v[6:7], v[6:7], v[54:55]
    s_waitcnt lgkmcnt(1)
    v_pk_add_f32 v[8:9], v[8:9], v[56:57]
    v_pk_add_f32 v[10:11], v[10:11], v[58:59]
    s_waitcnt lgkmcnt(0)
    v_pk_add_f32 v[12:13], v[12:13], v[60:61]
    v_pk_add_f32 v[14:15], v[14:15], v[62:63]
    v_cvt_pk_bf16_f32 v16, v0, v1
    v_cvt_pk_bf16_f32 v17, v2, v3
    v_cvt_pk_bf16_f32 v18, v4, v5
    v_cvt_pk_bf16_f32 v19, v6, v7
    v_cvt_pk_bf16_f32 v20, v8, v9
    v_cvt_pk_bf16_f32 v21, v10, v11
    v_cvt_pk_bf16_f32 v22, v12, v13
    v_cvt_pk_bf16_f32 v23, v14, v15
    v_permlane32_swap_b32 v16, v18
    v_permlane32_swap_b32 v17, v19
    v_permlane32_swap_b32 v20, v22
    v_permlane32_swap_b32 v21, v23
    buffer_store_dwordx4 v[16:19], v117, s[48:51], s19 offen offset:0
    buffer_store_dwordx4 v[20:23], v117, s[48:51], s19 offen offset:32
FIN:
    s_or_b32 s3, s2, s66
    s_cmp_lg_u32 s3, 0
    s_cbranch_scc1 NOEP
    buffer_store_dword v251, v252, s[12:15], 0 offen
NOEP:
END:
    s_endpgm
P0S:
    s_sub_u32 s84, s84, 1
    s_nop 2
    s_cbranch_scc1 END
    s_sleep 8
    s_mov_b32 s93, 65536
    buffer_load_dwordx2 a[254:255], v107, s[12:15], s93 offen sc1
    s_waitcnt vmcnt(0)
    v_accvgpr_read_b32 v242, a254
    v_accvgpr_read_b32 v243, a255
    v_xor_b32 v242, s67, v242
    v_bitop3_b32 v242, s67, v243, v242 bitop3:0xbe
    v_cmp_ne_u32 vcc, 0, v242
    s_nop 3
    s_cbranch_vccnz P0S
    s_branch P0R
FCS:
    s_sub_u32 s84, s84, 1
    s_nop 1
    s_cbranch_scc1 END
    s_sleep 4
    s_mov_b32 s8, 131072
    buffer_load_dwordx4 v[108:111], v250, s[12:15], s8 offen sc1
    s_waitcnt vmcnt(0)
    v_xor_b32 v108, s67, v108
    v_bitop3_b32 v108, s67, v109, v108 bitop3:0xbe
    v_bitop3_b32 v108, s67, v110, v108 bitop3:0xbe
    v_bitop3_b32 v108, s67, v111, v108 bitop3:0xbe
    v_cmp_ne_u32 vcc, 0, v108
    s_nop 3
    s_cbranch_vccnz FCS
    s_branch FCR
KVS_:
    s_sub_u32 s84, s84, 1
    s_nop 6
    s_cbranch_scc1 END
    s_sleep 4
    buffer_load_dwordx4 v[192:195], v250, s[12:15], s25 offen offset:0 sc1
    buffer_load_dwordx4 v[196:199], v250, s[12:15], s25 offen offset:1024 sc1
    buffer_load_dwordx4 v[200:203], v250, s[12:15], s25 offen offset:2048 sc1
    buffer_load_dwordx4 v[204:207], v250, s[12:15], s25 offen offset:3072 sc1
    buffer_load_dwordx4 v[208:211], v250, s[12:15], s26 offen offset:0 sc1
    buffer_load_dwordx4 v[212:215], v250, s[12:15], s26 offen offset:1024 sc1
    buffer_load_dwordx4 v[216:219], v250, s[12:15], s26 offen offset:2048 sc1
    buffer_load_dwordx4 v[220:223], v250, s[12:15], s26 offen offset:3072 sc1
    buffer_load_dwordx4 v[224:227], v250, s[12:15], s27 offen offset:0 sc1
    buffer_load_dwordx4 v[228:231], v250, s[12:15], s27 offen offset:1024 sc1
    buffer_load_dwordx4 v[232:235], v250, s[12:15], s27 offen offset:2048 sc1
    buffer_load_dwordx4 v[236:239], v250, s[12:15], s27 offen offset:3072 sc1
    buffer_load_dwordx4 v[32:35], v250, s[12:15], s28 offen offset:0 sc1
    buffer_load_dwordx4 v[36:39], v250, s[12:15], s28 offen offset:1024 sc1
    buffer_load_dwordx4 v[40:43], v250, s[12:15], s28 offen offset:2048 sc1
    buffer_load_dwordx4 v[44:47], v250, s[12:15], s28 offen offset:3072 sc1
    s_waitcnt vmcnt(0)
    s_branch KVR
OBS:
    s_sub_u32 s84, s84, 1
    s_nop 1
    s_cbranch_scc1 END
    s_sleep 1
    buffer_load_dword v99, v98, s[12:15], s8 offen offset:1020 sc1
    s_add_u32 m0, s69, 0
    s_nop 0
    buffer_load_dwordx4 v250, s[12:15], s8 offen offset:0 sc1 lds
    buffer_load_dwordx4 v250, s[12:15], s8 offen offset:1024 sc1 lds
    buffer_load_dwordx4 v250, s[12:15], s8 offen offset:2048 sc1 lds
    buffer_load_dwordx4 v250, s[12:15], s8 offen offset:3072 sc1 lds
    s_add_u32 m0, s69, 4096
    s_nop 0
    buffer_load_dwordx4 v250, s[12:15], s9 offen offset:0 sc1 lds
    buffer_load_dwordx4 v250, s[12:15], s9 offen offset:1024 sc1 lds
    buffer_load_dwordx4 v250, s[12:15], s9 offen offset:2048 sc1 lds
    buffer_load_dwordx4 v250, s[12:15], s9 offen offset:3072 sc1 lds
    s_waitcnt vmcnt(0)
    v_cmp_eq_u32 vcc, -1, v99
    s_nop 3
    s_cbranch_vccnz OBS
    s_branch OBS_R
OBX:
    s_sub_u32 s84, s84, 1
    s_nop 6
    s_cbranch_scc1 END
    s_sleep 8
    s_waitcnt vmcnt(0)
    s_barrier
    s_branch OBS
STS:
    s_sub_u32 s84, s84, 1
    s_nop 1
    s_cbranch_scc1 END
    s_sleep 1
    buffer_load_dwordx4 v[128:131], v120, s[12:15], s10 offen offset:0 sc1
    buffer_load_dwordx4 v[132:135], v120, s[12:15], s10 offen offset:512 sc1
    buffer_load_dwordx4 v[136:139], v120, s[12:15], s10 offen offset:1024 sc1
    buffer_load_dwordx4 v[140:143], v120, s[12:15], s10 offen offset:1536 sc1
    buffer_load_dwordx4 v[144:147], v120, s[12:15], s10 offen offset:2048 sc1
    buffer_load_dwordx4 v[148:151], v120, s[12:15], s10 offen offset:2560 sc1
    buffer_load_dwordx4 v[152:155], v120, s[12:15], s10 offen offset:3072 sc1
    buffer_load_dwordx4 v[156:159], v120, s[12:15], s10 offen offset:3584 sc1
    s_waitcnt vmcnt(0)
    s_branch STP
IDLE:
    s_barrier
    v_lshlrev_b32 v242, 12, v241
    s_mov_b32 s42, 7340032
    s_add_u32 s3, s86, 655360
    buffer_load_dword v243, v242, s[40:43], s3 offen
    s_add_u32 s3, s86, 3670016
    buffer_load_dword v243, v242, s[40:43], s3 offen
    s_add_u32 s3, s86, 3932160
    buffer_load_dword v243, v242, s[40:43], s3 offen
    s_add_u32 s3, s86, 4194304
    buffer_load_dword v243, v242, s[40:43], s3 offen
    s_add_u32 s3, s86, 4325376
    buffer_load_dword v243, v242, s[40:43], s3 offen
    s_waitcnt vmcnt(0)
    s_branch FIN
G3S0:
    s_sub_u32 s84, s84, 1
    s_nop 1
    s_cbranch_scc1 END
    s_sleep 1
    buffer_load_dwordx4 v[128:131], v112, s[12:15], s25 offen offset:0 sc1
    buffer_load_dwordx4 v[132:135], v113, s[12:15], s25 offen offset:0 sc1
    buffer_load_dwordx4 v[136:139], v112, s[12:15], s25 offen offset:512 sc1
    buffer_load_dwordx4 v[140:143], v113, s[12:15], s25 offen offset:512 sc1
    buffer_load_dwordx4 v[144:147], v112, s[12:15], s26 offen offset:0 sc1
    buffer_load_dwordx4 v[148:151], v113, s[12:15], s26 offen offset:0 sc1
    buffer_load_dwordx4 v[152:155], v112, s[12:15], s26 offen offset:512 sc1
    buffer_load_dwordx4 v[156:159], v113, s[12:15], s26 offen offset:512 sc1
    buffer_load_dwordx4 v[160:163], v112, s[12:15], s27 offen offset:0 sc1
    buffer_load_dwordx4 v[164:167], v113, s[12:15], s27 offen offset:0 sc1
    buffer_load_dwordx4 v[168:171], v112, s[12:15], s27 offen offset:512 sc1
    buffer_load_dwordx4 v[172:175], v113, s[12:15], s27 offen offset:512 sc1
    buffer_load_dwordx4 v[176:179], v112, s[12:15], s28 offen offset:0 sc1
    buffer_load_dwordx4 v[180:183], v113, s[12:15], s28 offen offset:0 sc1
    buffer_load_dwordx4 v[184:187], v112, s[12:15], s28 offen offset:512 sc1
    buffer_load_dwordx4 v[188:191], v113, s[12:15], s28 offen offset:512 sc1
    s_waitcnt vmcnt(0)
    v_max3_u32 v90, v128, v132, v136
    v_max3_u32 v90, v90, v140, v140
    v_cmp_eq_u32 vcc, -1, v90
    s_nop 3
    s_cbranch_vccnz G3S0
    s_branch G3R0
G3S1:
    s_sub_u32 s84, s84, 1
    s_nop 3
    s_cbranch_scc1 END
    s_sleep 1
    buffer_load_dwordx4 v[144:147], v112, s[12:15], s26 offen offset:0 sc1
    buffer_load_dwordx4 v[148:151], v113, s[12:15], s26 offen offset:0 sc1
    buffer_load_dwordx4 v[152:155], v112, s[12:15], s26 offen offset:512 sc1
    buffer_load_dwordx4 v[156:159], v113, s[12:15], s26 offen offset:512 sc1
    s_waitcnt vmcnt(0)
    v_max3_u32 v90, v144, v148, v152
    v_max3_u32 v90, v90, v156, v156
    v_cmp_eq_u32 vcc, -1, v90
    s_nop 3
    s_cbranch_vccnz G3S1
    s_branch G3R1
G3S2:
    s_sub_u32 s84, s84, 1
    s_nop 2
    s_cbranch_scc1 END
    s_sleep 1
    buffer_load_dwordx4 v[160:163], v112, s[12:15], s27 offen offset:0 sc1
    buffer_load_dwordx4 v[164:167], v113, s[12:15], s27 offen offset:0 sc1
    buffer_load_dwordx4 v[168:171], v112, s[12:15], s27 offen offset:512 sc1
    buffer_load_dwordx4 v[172:175], v113, s[12:15], s27 offen offset:512 sc1
    s_waitcnt vmcnt(0)
    v_max3_u32 v90, v160, v164, v168
    v_max3_u32 v90, v90, v172, v172
    v_cmp_eq_u32 vcc, -1, v90
    s_nop 3
    s_cbranch_vccnz G3S2
    s_branch G3R2
G3S3:
    s_sub_u32 s84, s84, 1
    s_nop 3
    s_cbranch_scc1 END
    s_sleep 1
    buffer_load_dwordx4 v[176:179], v112, s[12:15], s28 offen offset:0 sc1
    buffer_load_dwordx4 v[180:183], v113, s[12:15], s28 offen offset:0 sc1
    buffer_load_dwordx4 v[184:187], v112, s[12:15], s28 offen offset:512 sc1
    buffer_load_dwordx4 v[188:191], v113, s[12:15], s28 offen offset:512 sc1
    s_waitcnt vmcnt(0)
    v_max3_u32 v90, v176, v180, v184
    v_max3_u32 v90, v90, v188, v188
    v_cmp_eq_u32 vcc, -1, v90
    s_nop 3
    s_cbranch_vccnz G3S3
    s_branch G3R3
G3S4:
    s_sub_u32 s84, s84, 1
    s_nop 3
    s_cbranch_scc1 END
    s_sleep 1
    buffer_load_dwordx4 v[128:131], v112, s[12:15], s29 offen offset:0 sc1
    buffer_load_dwordx4 v[132:135], v113, s[12:15], s29 offen offset:0 sc1
    buffer_load_dwordx4 v[136:139], v112, s[12:15], s29 offen offset:512 sc1
    buffer_load_dwordx4 v[140:143], v113, s[12:15], s29 offen offset:512 sc1
    s_waitcnt vmcnt(0)
    v_max3_u32 v90, v128, v132, v136
    v_max3_u32 v90, v90, v140, v140
    v_cmp_eq_u32 vcc, -1, v90
    s_nop 3
    s_cbranch_vccnz G3S4
    s_branch G3R4
G3S5:
    s_sub_u32 s84, s84, 1
    s_nop 3
    s_cbranch_scc1 END
    s_sleep 1
    buffer_load_dwordx4 v[144:147], v112, s[12:15], s30 offen offset:0 sc1
    buffer_load_dwordx4 v[148:151], v113, s[12:15], s30 offen offset:0 sc1
    buffer_load_dwordx4 v[152:155], v112, s[12:15], s30 offen offset:512 sc1
    buffer_load_dwordx4 v[156:159], v113, s[12:15], s30 offen offset:512 sc1
    s_waitcnt vmcnt(0)
    v_max3_u32 v90, v144, v148, v152
    v_max3_u32 v90, v90, v156, v156
    v_cmp_eq_u32 vcc, -1, v90
    s_nop 3
    s_cbranch_vccnz G3S5
    s_branch G3R5
G3S6:
    s_sub_u32 s84, s84, 1
    s_nop 3
    s_cbranch_scc1 END
    s_sleep 1
    buffer_load_dwordx4 v[160:163], v112, s[12:15], s31 offen offset:0 sc1
    buffer_load_dwordx4 v[164:167], v113, s[12:15], s31 offen offset:0 sc1
    buffer_load_dwordx4 v[168:171], v112, s[12:15], s31 offen offset:512 sc1
    buffer_load_dwordx4 v[172:175], v113, s[12:15], s31 offen offset:512 sc1
    s_waitcnt vmcnt(0)
    v_max3_u32 v90, v160, v164, v168
    v_max3_u32 v90, v90, v172, v172
    v_cmp_eq_u32 vcc, -1, v90
    s_nop 3
    s_cbranch_vccnz G3S6
    s_branch G3R6
G3S7:
    s_sub_u32 s84, s84, 1
    s_nop 3
    s_cbranch_scc1 END
    s_sleep 1
    buffer_load_dwordx4 v[176:179], v112, s[12:15], s32 offen offset:0 sc1
    buffer_load_dwordx4 v[180:183], v113, s[12:15], s32 offen offset:0 sc1
    buffer_load_dwordx4 v[184:187], v112, s[12:15], s32 offen offset:512 sc1
    buffer_load_dwordx4 v[188:191], v113, s[12:15], s32 offen offset:512 sc1
    s_waitcnt vmcnt(0)
    v_max3_u32 v90, v176, v180, v184
    v_max3_u32 v90, v90, v188, v188
    v_cmp_eq_u32 vcc, -1, v90
    s_nop 3
    s_cbranch_vccnz G3S7
    s_branch G3R7
G3S8:
    s_sub_u32 s84, s84, 1
    s_nop 3
    s_cbranch_scc1 END
    s_sleep 1
    buffer_load_dwordx4 v[128:131], v122, s[12:15], s25 offen offset:0 sc1
    buffer_load_dwordx4 v[132:135], v123, s[12:15], s25 offen offset:0 sc1
    buffer_load_dwordx4 v[136:139], v122, s[12:15], s25 offen offset:512 sc1
    buffer_load_dwordx4 v[140:143], v123, s[12:15], s25 offen offset:512 sc1
    s_waitcnt vmcnt(0)
    v_max3_u32 v90, v128, v132, v136
    v_max3_u32 v90, v90, v140, v140
    v_cmp_eq_u32 vcc, -1, v90
    s_nop 3
    s_cbranch_vccnz G3S8
    s_branch G3R8
G3S9:
    s_sub_u32 s84, s84, 1
    s_nop 4
    s_cbranch_scc1 END
    s_sleep 1
    buffer_load_dwordx4 v[144:147], v122, s[12:15], s26 offen offset:0 sc1
    buffer_load_dwordx4 v[148:151], v123, s[12:15], s26 offen offset:0 sc1
    buffer_load_dwordx4 v[152:155], v122, s[12:15], s26 offen offset:512 sc1
    buffer_load_dwordx4 v[156:159], v123, s[12:15], s26 offen offset:512 sc1
    s_waitcnt vmcnt(0)
    v_max3_u32 v90, v144, v148, v152
    v_max3_u32 v90, v90, v156, v156
    v_cmp_eq_u32 vcc, -1, v90
    s_nop 3
    s_cbranch_vccnz G3S9
    s_branch G3R9
G3S10:
    s_sub_u32 s84, s84, 1
    s_nop 4
    s_cbranch_scc1 END
    s_sleep 1
    buffer_load_dwordx4 v[160:163], v122, s[12:15], s27 offen offset:0 sc1
    buffer_load_dwordx4 v[164:167], v123, s[12:15], s27 offen offset:0 sc1
    buffer_load_dwordx4 v[168:171], v122, s[12:15], s27 offen offset:512 sc1
    buffer_load_dwordx4 v[172:175], v123, s[12:15], s27 offen offset:512 sc1
    s_waitcnt vmcnt(0)
    v_max3_u32 v90, v160, v164, v168
    v_max3_u32 v90, v90, v172, v172
    v_cmp_eq_u32 vcc, -1, v90
    s_nop 3
    s_cbranch_vccnz G3S10
    s_branch G3R10
G3S11:
    s_sub_u32 s84, s84, 1
    s_nop 4
    s_cbranch_scc1 END
    s_sleep 1
    buffer_load_dwordx4 v[176:179], v122, s[12:15], s28 offen offset:0 sc1
    buffer_load_dwordx4 v[180:183], v123, s[12:15], s28 offen offset:0 sc1
    buffer_load_dwordx4 v[184:187], v122, s[12:15], s28 offen offset:512 sc1
    buffer_load_dwordx4 v[188:191], v123, s[12:15], s28 offen offset:512 sc1
    s_waitcnt vmcnt(0)
    v_max3_u32 v90, v176, v180, v184
    v_max3_u32 v90, v90, v188, v188
    v_cmp_eq_u32 vcc, -1, v90
    s_nop 3
    s_cbranch_vccnz G3S11
    s_branch G3R11
G3S12:
    s_sub_u32 s84, s84, 1
    s_nop 4
    s_cbranch_scc1 END
    s_sleep 1
    buffer_load_dwordx4 v[128:131], v123, s[12:15], s29 offen offset:0 sc1
    buffer_load_dwordx4 v[132:135], v123, s[12:15], s29 offen offset:512 sc1
    buffer_load_dwordx4 v[136:139], v123, s[12:15], s30 offen offset:0 sc1
    buffer_load_dwordx4 v[140:143], v123, s[12:15], s30 offen offset:512 sc1
    s_waitcnt vmcnt(0)
    v_max3_u32 v90, v128, v132, v136
    v_max3_u32 v90, v90, v140, v140
    v_cmp_eq_u32 vcc, -1, v90
    s_nop 3
    s_cbranch_vccnz G3S12
    s_branch G3R12
G3S13:
    s_sub_u32 s84, s84, 1
    s_nop 5
    s_cbranch_scc1 END
    s_sleep 1
    buffer_load_dwordx4 v[144:147], v123, s[12:15], s31 offen offset:0 sc1
    buffer_load_dwordx4 v[148:151], v123, s[12:15], s31 offen offset:512 sc1
    buffer_load_dwordx4 v[152:155], v123, s[12:15], s32 offen offset:0 sc1
    buffer_load_dwordx4 v[156:159], v123, s[12:15], s32 offen offset:512 sc1
    s_waitcnt vmcnt(0)
    v_max3_u32 v90, v144, v148, v152
    v_max3_u32 v90, v90, v156, v156
    v_cmp_eq_u32 vcc, -1, v90
    s_nop 3
    s_cbranch_vccnz G3S13
    s_branch G3R13
G3S14:
    s_sub_u32 s84, s84, 1
    s_nop 5
    s_cbranch_scc1 END
    s_sleep 1
    buffer_load_dwordx4 v[160:163], v122, s[12:15], s29 offen offset:0 sc1
    buffer_load_dwordx4 v[164:167], v122, s[12:15], s29 offen offset:512 sc1
    buffer_load_dwordx4 v[168:171], v122, s[12:15], s30 offen offset:0 sc1
    buffer_load_dwordx4 v[172:175], v122, s[12:15], s30 offen offset:512 sc1
    s_waitcnt vmcnt(0)
    v_max3_u32 v90, v160, v164, v168
    v_max3_u32 v90, v90, v172, v172
    v_cmp_eq_u32 vcc, -1, v90
    s_nop 3
    s_cbranch_vccnz G3S14
    s_branch G3R14
G3S15:
    s_sub_u32 s84, s84, 1
    s_nop 4
    s_cbranch_scc1 END
    s_sleep 1
    buffer_load_dwordx4 v[176:179], v122, s[12:15], s31 offen offset:0 sc1
    buffer_load_dwordx4 v[180:183], v122, s[12:15], s31 offen offset:512 sc1
    buffer_load_dwordx4 v[184:187], v122, s[12:15], s32 offen offset:0 sc1
    buffer_load_dwordx4 v[188:191], v122, s[12:15], s32 offen offset:512 sc1
    s_waitcnt vmcnt(0)
    v_max3_u32 v90, v176, v180, v184
    v_max3_u32 v90, v90, v188, v188
    v_cmp_eq_u32 vcc, -1, v90
    s_nop 3
    s_cbranch_vccnz G3S15
    s_branch G3R15
FSS:
    s_sub_u32 s84, s84, 1
    s_cbranch_scc1 END
    s_sleep 2
    buffer_load_dwordx4 v[192:195], v206, s[12:15], s9 offen offset:0 sc1
    buffer_load_dwordx4 v[196:199], v206, s[12:15], s9 offen offset:512 sc1
    buffer_load_dwordx4 v[200:203], v205, s[12:15], s8 offen sc1
    s_waitcnt vmcnt(0)
    v_xor_b32 v242, s67, v202
    v_bitop3_b32 v242, s68, v203, v242 bitop3:0xbe
    v_cmp_ne_u32 s[62:63], 0, v242
    v_max3_u32 v90, v192, v196, v196
    v_cmp_eq_u32 vcc, -1, v90
    s_nop 1
    s_or_b64 vcc, vcc, s[62:63]
    s_nop 0
    s_cbranch_vccnz FSS
    s_branch FSR
G4S0:
    s_sub_u32 s84, s84, 1
    s_nop 1
    s_cbranch_scc1 END
    s_sleep 1
    buffer_load_dwordx4 v[128:131], v112, s[12:15], s25 offen offset:0 sc1
    buffer_load_dwordx4 v[132:135], v113, s[12:15], s25 offen offset:0 sc1
    buffer_load_dwordx4 v[136:139], v112, s[12:15], s25 offen offset:512 sc1
    buffer_load_dwordx4 v[140:143], v113, s[12:15], s25 offen offset:512 sc1
    buffer_load_dwordx4 v[144:147], v112, s[12:15], s25 offen offset:1024 sc1
    buffer_load_dwordx4 v[148:151], v113, s[12:15], s25 offen offset:1024 sc1
    buffer_load_dwordx4 v[152:155], v112, s[12:15], s25 offen offset:1536 sc1
    buffer_load_dwordx4 v[156:159], v113, s[12:15], s25 offen offset:1536 sc1
    buffer_load_dwordx4 v[160:163], v112, s[12:15], s25 offen offset:2048 sc1
    buffer_load_dwordx4 v[164:167], v113, s[12:15], s25 offen offset:2048 sc1
    buffer_load_dwordx4 v[168:171], v112, s[12:15], s25 offen offset:2560 sc1
    buffer_load_dwordx4 v[172:175], v113, s[12:15], s25 offen offset:2560 sc1
    buffer_load_dwordx4 v[176:179], v112, s[12:15], s25 offen offset:3072 sc1
    buffer_load_dwordx4 v[180:183], v113, s[12:15], s25 offen offset:3072 sc1
    buffer_load_dwordx4 v[184:187], v112, s[12:15], s25 offen offset:3584 sc1
    buffer_load_dwordx4 v[188:191], v113, s[12:15], s25 offen offset:3584 sc1
    s_waitcnt vmcnt(0)
    v_max3_u32 v90, v128, v132, v136
    v_max3_u32 v90, v90, v140, v140
    v_cmp_eq_u32 vcc, -1, v90
    s_nop 3
    s_cbranch_vccnz G4S0
    s_branch G4R0
G4S1:
    s_sub_u32 s84, s84, 1
    s_nop 4
    s_cbranch_scc1 END
    s_sleep 1
    buffer_load_dwordx4 v[144:147], v112, s[12:15], s25 offen offset:1024 sc1
    buffer_load_dwordx4 v[148:151], v113, s[12:15], s25 offen offset:1024 sc1
    buffer_load_dwordx4 v[152:155], v112, s[12:15], s25 offen offset:1536 sc1
    buffer_load_dwordx4 v[156:159], v113, s[12:15], s25 offen offset:1536 sc1
    s_waitcnt vmcnt(0)
    v_max3_u32 v90, v144, v148, v152
    v_max3_u32 v90, v90, v156, v156
    v_cmp_eq_u32 vcc, -1, v90
    s_nop 3
    s_cbranch_vccnz G4S1
    s_branch G4R1
G4S2:
    s_sub_u32 s84, s84, 1
    s_nop 4
    s_cbranch_scc1 END
    s_sleep 1
    buffer_load_dwordx4 v[160:163], v112, s[12:15], s25 offen offset:2048 sc1
    buffer_load_dwordx4 v[164:167], v113, s[12:15], s25 offen offset:2048 sc1
    buffer_load_dwordx4 v[168:171], v112, s[12:15], s25 offen offset:2560 sc1
    buffer_load_dwordx4 v[172:175], v113, s[12:15], s25 offen offset:2560 sc1
    s_waitcnt vmcnt(0)
    v_max3_u32 v90, v160, v164, v168
    v_max3_u32 v90, v90, v172, v172
    v_cmp_eq_u32 vcc, -1, v90
    s_nop 3
    s_cbranch_vccnz G4S2
    s_branch G4R2
G4S3:
    s_sub_u32 s84, s84, 1
    s_nop 4
    s_cbranch_scc1 END
    s_sleep 1
    buffer_load_dwordx4 v[176:179], v112, s[12:15], s25 offen offset:3072 sc1
    buffer_load_dwordx4 v[180:183], v113, s[12:15], s25 offen offset:3072 sc1
    buffer_load_dwordx4 v[184:187], v112, s[12:15], s25 offen offset:3584 sc1
    buffer_load_dwordx4 v[188:191], v113, s[12:15], s25 offen offset:3584 sc1
    s_waitcnt vmcnt(0)
    v_max3_u32 v90, v176, v180, v184
    v_max3_u32 v90, v90, v188, v188
    v_cmp_eq_u32 vcc, -1, v90
    s_nop 3
    s_cbranch_vccnz G4S3
    s_branch G4R3
G4S4:
    s_sub_u32 s84, s84, 1
    s_nop 4
    s_cbranch_scc1 END
    s_sleep 1
    buffer_load_dwordx4 v[128:131], v112, s[12:15], s26 offen offset:0 sc1
    buffer_load_dwordx4 v[132:135], v113, s[12:15], s26 offen offset:0 sc1
    buffer_load_dwordx4 v[136:139], v112, s[12:15], s26 offen offset:512 sc1
    buffer_load_dwordx4 v[140:143], v113, s[12:15], s26 offen offset:512 sc1
    s_waitcnt vmcnt(0)
    v_max3_u32 v90, v128, v132, v136
    v_max3_u32 v90, v90, v140, v140
    v_cmp_eq_u32 vcc, -1, v90
    s_nop 3
    s_cbranch_vccnz G4S4
    s_branch G4R4
G4S5:
    s_sub_u32 s84, s84, 1
    s_nop 4
    s_cbranch_scc1 END
    s_sleep 1
    buffer_load_dwordx4 v[144:147], v112, s[12:15], s26 offen offset:1024 sc1
    buffer_load_dwordx4 v[148:151], v113, s[12:15], s26 offen offset:1024 sc1
    buffer_load_dwordx4 v[152:155], v112, s[12:15], s26 offen offset:1536 sc1
    buffer_load_dwordx4 v[156:159], v113, s[12:15], s26 offen offset:1536 sc1
    s_waitcnt vmcnt(0)
    v_max3_u32 v90, v144, v148, v152
    v_max3_u32 v90, v90, v156, v156
    v_cmp_eq_u32 vcc, -1, v90
    s_nop 3
    s_cbranch_vccnz G4S5
    s_branch G4R5
G4S6:
    s_sub_u32 s84, s84, 1
    s_nop 4
    s_cbranch_scc1 END
    s_sleep 1
    buffer_load_dwordx4 v[160:163], v112, s[12:15], s26 offen offset:2048 sc1
    buffer_load_dwordx4 v[164:167], v113, s[12:15], s26 offen offset:2048 sc1
    buffer_load_dwordx4 v[168:171], v112, s[12:15], s26 offen offset:2560 sc1
    buffer_load_dwordx4 v[172:175], v113, s[12:15], s26 offen offset:2560 sc1
    s_waitcnt vmcnt(0)
    v_max3_u32 v90, v160, v164, v168
    v_max3_u32 v90, v90, v172, v172
    v_cmp_eq_u32 vcc, -1, v90
    s_nop 3
    s_cbranch_vccnz G4S6
    s_branch G4R6
G4S7:
    s_sub_u32 s84, s84, 1
    s_nop 4
    s_cbranch_scc1 END
    s_sleep 1
    buffer_load_dwordx4 v[176:179], v112, s[12:15], s27 offen offset:0 sc1
    buffer_load_dwordx4 v[180:183], v113, s[12:15], s27 offen offset:0 sc1
    buffer_load_dwordx4 v[184:187], v112, s[12:15], s27 offen offset:512 sc1
    buffer_load_dwordx4 v[188:191], v113, s[12:15], s27 offen offset:512 sc1
    s_waitcnt vmcnt(0)
    v_max3_u32 v90, v176, v180, v184
    v_max3_u32 v90, v90, v188, v188
    v_cmp_eq_u32 vcc, -1, v90
    s_nop 3
    s_cbranch_vccnz G4S7
    s_branch G4R7
G4S8:
    s_sub_u32 s84, s84, 1
    s_nop 4
    s_cbranch_scc1 END
    s_sleep 1
    buffer_load_dwordx4 v[128:131], v112, s[12:15], s27 offen offset:1024 sc1
    buffer_load_dwordx4 v[132:135], v113, s[12:15], s27 offen offset:1024 sc1
    buffer_load_dwordx4 v[136:139], v112, s[12:15], s27 offen offset:1536 sc1
    buffer_load_dwordx4 v[140:143], v113, s[12:15], s27 offen offset:1536 sc1
    s_waitcnt vmcnt(0)
    v_max3_u32 v90, v128, v132, v136
    v_max3_u32 v90, v90, v140, v140
    v_cmp_eq_u32 vcc, -1, v90
    s_nop 3
    s_cbranch_vccnz G4S8
    s_branch G4R8
G4S9:
    s_sub_u32 s84, s84, 1
    s_nop 4
    s_cbranch_scc1 END
    s_sleep 1
    buffer_load_dwordx4 v[144:147], v112, s[12:15], s27 offen offset:2048 sc1
    buffer_load_dwordx4 v[148:151], v113, s[12:15], s27 offen offset:2048 sc1
    buffer_load_dwordx4 v[152:155], v112, s[12:15], s27 offen offset:2560 sc1
    buffer_load_dwordx4 v[156:159], v113, s[12:15], s27 offen offset:2560 sc1
    s_waitcnt vmcnt(0)
    v_max3_u32 v90, v144, v148, v152
    v_max3_u32 v90, v90, v156, v156
    v_cmp_eq_u32 vcc, -1, v90
    s_nop 3
    s_cbranch_vccnz G4S9
    s_branch G4R9
G4S10:
    s_sub_u32 s84, s84, 1
    s_nop 4
    s_cbranch_scc1 END
    s_sleep 1
    buffer_load_dwordx4 v[160:163], v113, s[12:15], s27 offen offset:3072 sc1
    buffer_load_dwordx4 v[164:167], v113, s[12:15], s27 offen offset:3584 sc1
    buffer_load_dwordx4 v[168:171], v113, s[12:15], s28 offen offset:0 sc1
    buffer_load_dwordx4 v[172:175], v113, s[12:15], s28 offen offset:512 sc1
    s_waitcnt vmcnt(0)
    v_max3_u32 v90, v160, v164, v168
    v_max3_u32 v90, v90, v172, v172
    v_cmp_eq_u32 vcc, -1, v90
    s_nop 3
    s_cbranch_vccnz G4S10
    s_branch G4R10
G4S11:
    s_sub_u32 s84, s84, 1
    s_nop 5
    s_cbranch_scc1 END
    s_sleep 1
    buffer_load_dwordx4 v[176:179], v113, s[12:15], s28 offen offset:1024 sc1
    buffer_load_dwordx4 v[180:183], v113, s[12:15], s28 offen offset:1536 sc1
    buffer_load_dwordx4 v[184:187], v113, s[12:15], s28 offen offset:2048 sc1
    buffer_load_dwordx4 v[188:191], v113, s[12:15], s28 offen offset:2560 sc1
    s_waitcnt vmcnt(0)
    v_max3_u32 v90, v176, v180, v184
    v_max3_u32 v90, v90, v188, v188
    v_cmp_eq_u32 vcc, -1, v90
    s_nop 3
    s_cbranch_vccnz G4S11
    s_branch G4R11
G4S12:
    s_sub_u32 s84, s84, 1
    s_nop 5
    s_cbranch_scc1 END
    s_sleep 1
    buffer_load_dwordx4 v[128:131], v112, s[12:15], s27 offen offset:3072 sc1
    buffer_load_dwordx4 v[132:135], v112, s[12:15], s27 offen offset:3584 sc1
    buffer_load_dwordx4 v[136:139], v112, s[12:15], s28 offen offset:0 sc1
    buffer_load_dwordx4 v[140:143], v112, s[12:15], s28 offen offset:512 sc1
    s_waitcnt vmcnt(0)
    v_max3_u32 v90, v128, v132, v136
    v_max3_u32 v90, v90, v140, v140
    v_cmp_eq_u32 vcc, -1, v90
    s_nop 3
    s_cbranch_vccnz G4S12
    s_branch G4R12
G4S13:
    s_sub_u32 s84, s84, 1
    s_nop 4
    s_cbranch_scc1 END
    s_sleep 1
    buffer_load_dwordx4 v[144:147], v112, s[12:15], s28 offen offset:1024 sc1
    buffer_load_dwordx4 v[148:151], v112, s[12:15], s28 offen offset:1536 sc1
    buffer_load_dwordx4 v[152:155], v112, s[12:15], s28 offen offset:2048 sc1
    buffer_load_dwordx4 v[156:159], v112, s[12:15], s28 offen offset:2560 sc1
    s_waitcnt vmcnt(0)
    v_max3_u32 v90, v144, v148, v152
    v_max3_u32 v90, v90, v156, v156
    v_cmp_eq_u32 vcc, -1, v90
    s_nop 3
    s_cbranch_vccnz G4S13
    s_branch G4R13
CODE_END:
.section .rodata,"a"
.p2align 6
.amdhsa_kernel sequential_preLN__linear_kernel_hedgehog__mixer_token_mlp__prompt_kernel
  .amdhsa_next_free_vgpr 512
  .amdhsa_next_free_sgpr 102
  .amdhsa_accum_offset 256
  .amdhsa_group_segment_fixed_size 0
  .amdhsa_kernarg_size 96
  .amdhsa_user_sgpr_count 2
  .amdhsa_user_sgpr_kernarg_segment_ptr 1
  .amdhsa_system_sgpr_workgroup_id_x 1
.end_amdhsa_kernel
```
